```python
import torch

def _softmax(x, axis=-1):
    return torch.softmax(x, dim=axis)
def _gelu(x):
    return torch.nn.functional.gelu(x, approximate="tanh")
def _silu(x):
    return torch.nn.functional.silu(x)
def _sigmoid(x):
    return torch.sigmoid(x)
def _layernorm(x, axis=-1, eps=1e-5):
    m = x.mean(dim=axis, keepdim=True)
    v = x.var(dim=axis, keepdim=True, unbiased=False)
    return (x - m) / torch.sqrt(v + eps)
def _scatter_add(tgt, idx, src, axis=0):
    return tgt.clone().index_add_(axis, idx, src)
def _segment_sum(src, seg, n):
    out = torch.zeros((n,) + src.shape[1:], dtype=src.dtype)
    return out.index_add_(0, seg, src)
def _pad(x, pw):
    flat = tuple(v for pair in reversed(pw) for v in pair)
    return torch.nn.functional.pad(x, flat)

kernel_name = 'gather_scatter__edge_featured_mpnn_gatedgcn__graph'

def setup_inputs():

    _w = (lambda a: (lambda t: t.to(torch.bfloat16) if t.is_floating_point() else t)(torch.as_tensor(a)))
    N, deg, D, De = 10000, 16, 128, max(16, 1)
    E = N * deg
    return {
        "x": _w((lambda *s: torch.randn(*s, dtype=torch.bfloat16) * 0.4)(N, D)),
        "e_attr": _w((lambda *s: torch.randn(*s, dtype=torch.bfloat16) * 0.4)(E, De)),
        "src": _w((lambda lo, hi, *s: torch.randint(lo, hi, s))(0, N, E).to(torch.int64)),
        "dst": _w((lambda lo, hi, *s: torch.randint(lo, hi, s))(0, N, E).to(torch.int64)),
        "w_a": _w((lambda *s: torch.randn(*s, dtype=torch.bfloat16) * 0.4)(D, D)),
        "w_b": _w((lambda *s: torch.randn(*s, dtype=torch.bfloat16) * 0.4)(D, D)),
        "w_c": _w((lambda *s: torch.randn(*s, dtype=torch.bfloat16) * 0.4)(De, D)),
        "w_u": _w((lambda *s: torch.randn(*s, dtype=torch.bfloat16) * 0.05)(D, D)),
        "w_v": _w((lambda *s: torch.randn(*s, dtype=torch.bfloat16) * 0.05)(D, D)),
    }

def reference(x, e_attr, src, dst, w_a, w_b, w_c, w_u, w_v):
    N, D = x.shape
    hv = x @ w_v
    g = x[dst] @ w_a + x[src] @ w_b + e_attr @ w_c
    eta = _sigmoid(g)
    denom = _segment_sum(eta, dst, N) + 1e-6
    eta_n = eta / denom[dst]
    agg = _segment_sum(eta_n * hv[src], dst, N)
    z = x @ w_u + agg
    relu_z = torch.where(z > 0, z, 0 * z)
    return x + relu_z
```

```asm
; @launch kernel=prep_kernel grid=(256,1,1) block=(896,1,1) lds=84992
; @launch kernel=gather_scatter__edge_featured_mpnn_gatedgcn__graph_kernel grid=(256,1,1) block=(512,1,1) lds=163376
.amdgcn_target "amdgcn-amd-amdhsa--gfx950"
.text
.globl prep_kernel
.p2align 8
.type prep_kernel,@function
prep_kernel:
  s_cmp_ge_u32 s2, 256
  s_cbranch_scc1 K1_done
  s_getpc_b64 s[40:41]
K1_pc0:
  s_sub_u32 s40, s40, K1_pc0 - prep_kernel
  s_subb_u32 s41, s41, 0
  s_mov_b32 s42, K1_codeend - prep_kernel
  s_mov_b32 s43, 0x00020000
  v_lshlrev_b32 v120, 7, v0
  v_cmp_gt_u32 vcc, 64, v0
  s_and_saveexec_b64 s[44:45], vcc
  s_cbranch_execz K1_nospf
  buffer_load_dword v121, v120, s[40:43], 0 offen
K1_nospf:
  s_mov_b64 exec, s[44:45]
  s_load_dwordx8 s[4:11], s[0:1], 0
  s_load_dwordx2 s[12:13], s[0:1], 40
  s_load_dwordx2 s[14:15], s[0:1], 64
  s_load_dwordx2 s[16:17], s[0:1], 88
  s_lshr_b32 s18, s2, 4
  s_lshl_b32 s18, s18, 3
  s_and_b32 s19, s2, 7
  s_add_u32 s18, s18, s19
  s_bfe_u32 s19, s2, 0x10003
  s_cmp_ge_u32 s18, 125
  s_cbranch_scc1 K1_done
  v_lshrrev_b32 v1, 6, v0
  v_and_b32 v2, 63, v0
  v_readfirstlane_b32 s3, v1
  s_nop 3
  s_sub_u32 s21, s3, 1
  s_cmp_le_u32 s3, 12
  s_cselect_b32 s21, s21, s3
  s_cmp_eq_u32 s3, 0
  s_cselect_b32 s3, 12, s21
  s_lshl_b32 s20, s18, 1
  s_add_u32 s20, s20, s19
  v_lshrrev_b32 v6, 4, v2
  s_lshl_b32 s21, s3, 3
  v_add_u32 v6, s21, v6
  v_xor_b32 v7, v6, v2
  v_and_b32 v7, 15, v7
  v_lshlrev_b32 v7, 4, v7
  v_lshl_add_u32 v10, v6, 8, v7
  v_add_u32 v6, 4, v6
  v_xor_b32 v7, v6, v2
  v_and_b32 v7, 15, v7
  v_lshlrev_b32 v7, 4, v7
  v_lshl_add_u32 v11, v6, 8, v7
  s_cmp_eq_u32 s3, 13
  s_cbranch_scc1 K1_pf
  s_cmp_eq_u32 s3, 12
  s_cbranch_scc1 K1_sort
  v_lshrrev_b32 v3, 3, v2
  v_bfe_u32 v4, v2, 4, 1
  v_lshlrev_b32 v4, 2, v4
  v_and_b32 v5, 7, v2
  v_xor_b32 v4, v4, v5
  v_lshlrev_b32 v3, 8, v3
  v_lshl_add_u32 v3, v4, 4, v3
  s_waitcnt lgkmcnt(0)
  s_mov_b32 s24, s4
  s_mov_b32 s25, s5
  s_mov_b32 s26, 2560000
  s_mov_b32 s27, 0x00020000
  s_mul_i32 s22, s18, 20480
  s_lshl_b32 s23, s3, 11
  s_add_u32 m0, s23, 32768
  s_nop 0
  buffer_load_dwordx4 v10, s[24:27], s22 offen lds
  s_add_u32 m0, s23, 33792
  s_nop 0
  buffer_load_dwordx4 v11, s[24:27], s22 offen lds
  s_add_u32 s21, s3, 0
  s_cmp_lt_u32 s21, 16
  s_cselect_b32 s28, s12, s14
  s_cselect_b32 s29, s13, s15
  s_mov_b32 s30, 32768
  s_mov_b32 s31, 0x00020000
  s_and_b32 s23, s21, 15
  s_lshl_b32 s23, s23, 11
  s_lshl_b32 s33, s19, 7
  s_add_u32 s23, s23, s33
  s_lshl_b32 s21, s21, 10
  s_add_u32 m0, s21, 0
  s_nop 0
  buffer_load_dwordx4 v3, s[28:31], s23 offen lds
  s_add_u32 s21, s3, 12
  s_cmp_lt_u32 s21, 16
  s_cselect_b32 s28, s12, s14
  s_cselect_b32 s29, s13, s15
  s_mov_b32 s30, 32768
  s_mov_b32 s31, 0x00020000
  s_and_b32 s23, s21, 15
  s_lshl_b32 s23, s23, 11
  s_lshl_b32 s33, s19, 7
  s_add_u32 s23, s23, s33
  s_lshl_b32 s21, s21, 10
  s_add_u32 m0, s21, 0
  s_nop 0
  buffer_load_dwordx4 v3, s[28:31], s23 offen lds
  s_cmp_ge_u32 s3, 8
  s_cbranch_scc1 K1_wdone
  s_add_u32 s21, s3, 24
  s_cmp_lt_u32 s21, 16
  s_cselect_b32 s28, s12, s14
  s_cselect_b32 s29, s13, s15
  s_mov_b32 s30, 32768
  s_mov_b32 s31, 0x00020000
  s_and_b32 s23, s21, 15
  s_lshl_b32 s23, s23, 11
  s_lshl_b32 s33, s19, 7
  s_add_u32 s23, s23, s33
  s_lshl_b32 s21, s21, 10
  s_add_u32 m0, s21, 0
  s_nop 0
  buffer_load_dwordx4 v3, s[28:31], s23 offen lds
K1_wdone:
  s_lshr_b32 s34, s3, 2
  s_and_b32 s35, s3, 1
  s_bfe_u32 s36, s3, 0x10001
  v_lshrrev_b32 v13, 5, v2
  v_bfe_u32 v14, v2, 2, 2
  v_lshl_add_u32 v12, v13, 3, v14
  v_lshlrev_b32 v12, 7, v12
  v_and_b32 v14, 1, v2
  v_lshlrev_b32 v14, 5, v14
  v_bfe_u32 v15, v2, 4, 1
  v_lshl_add_u32 v14, v15, 4, v14
  v_bfe_u32 v15, v2, 1, 1
  v_lshl_add_u32 v14, v15, 3, v14
  s_lshl_b32 s21, s36, 6
  v_add_u32 v14, s21, v14
  v_bfe_u32 v15, v2, 3, 1
  v_lshlrev_b32 v15, 6, v15
  v_xor_b32 v14, v14, v15
  v_add_u32 v12, v12, v14
  s_lshl_b32 s21, s35, 14
  v_add_u32 v12, s21, v12
  v_and_b32 v14, 31, v2
  s_lshl_b32 s21, s34, 5
  v_add_u32 v15, s21, v14
  v_xor_b32 v17, v15, v13
  v_and_b32 v17, 15, v17
  v_lshlrev_b32 v17, 4, v17
  v_lshl_add_u32 v16, v15, 8, v17
  v_add_u32 v16, 32768, v16
  s_lshl_b32 s21, s36, 3
  s_lshl_b32 s23, s35, 2
  s_add_u32 s21, s21, s23
  v_lshl_add_u32 v17, v13, 1, s21
  v_xor_b32 v17, v17, v15
  v_and_b32 v17, 15, v17
  v_lshlrev_b32 v17, 4, v17
  v_lshl_add_u32 v18, v15, 8, v17
  v_add_u32 v18, 57344, v18
  v_xor_b32 v19, 16, v18
  s_movk_i32 s21, 80
  v_cmp_gt_u32 s[38:39], s21, v15
  s_waitcnt vmcnt(0)
  s_barrier
  ds_read_b64_tr_b16 v[32:33], v12 offset:0
  ds_read_b64_tr_b16 v[34:35], v12 offset:512
  ds_read_b128 v[64:67], v16
  ds_read_b64_tr_b16 v[36:37], v12 offset:2048
  ds_read_b64_tr_b16 v[38:39], v12 offset:2560
  v_xor_b32 v20, 32, v16
  ds_read_b128 v[68:71], v20
  ds_read_b64_tr_b16 v[40:41], v12 offset:4096
  ds_read_b64_tr_b16 v[42:43], v12 offset:4608
  v_xor_b32 v20, 64, v16
  ds_read_b128 v[72:75], v20
  ds_read_b64_tr_b16 v[44:45], v12 offset:6144
  ds_read_b64_tr_b16 v[46:47], v12 offset:6656
  v_xor_b32 v20, 96, v16
  ds_read_b128 v[76:79], v20
  s_waitcnt lgkmcnt(9)
  v_mfma_f32_32x32x16_bf16 v[96:111], v[32:35], v[64:67], 0
  ds_read_b64_tr_b16 v[48:49], v12 offset:8192
  ds_read_b64_tr_b16 v[50:51], v12 offset:8704
  v_xor_b32 v20, 128, v16
  ds_read_b128 v[80:83], v20
  s_waitcnt lgkmcnt(9)
  v_mfma_f32_32x32x16_bf16 v[96:111], v[36:39], v[68:71], v[96:111]
  ds_read_b64_tr_b16 v[52:53], v12 offset:10240
  ds_read_b64_tr_b16 v[54:55], v12 offset:10752
  v_xor_b32 v20, 160, v16
  ds_read_b128 v[84:87], v20
  s_waitcnt lgkmcnt(9)
  v_mfma_f32_32x32x16_bf16 v[96:111], v[40:43], v[72:75], v[96:111]
  ds_read_b64_tr_b16 v[56:57], v12 offset:12288
  ds_read_b64_tr_b16 v[58:59], v12 offset:12800
  v_xor_b32 v20, 192, v16
  ds_read_b128 v[88:91], v20
  s_waitcnt lgkmcnt(9)
  v_mfma_f32_32x32x16_bf16 v[96:111], v[44:47], v[76:79], v[96:111]
  ds_read_b64_tr_b16 v[60:61], v12 offset:14336
  ds_read_b64_tr_b16 v[62:63], v12 offset:14848
  v_xor_b32 v20, 224, v16
  ds_read_b128 v[92:95], v20
  s_waitcnt lgkmcnt(9)
  v_mfma_f32_32x32x16_bf16 v[96:111], v[48:51], v[80:83], v[96:111]
  s_waitcnt lgkmcnt(6)
  v_mfma_f32_32x32x16_bf16 v[96:111], v[52:55], v[84:87], v[96:111]
  s_waitcnt lgkmcnt(3)
  v_mfma_f32_32x32x16_bf16 v[96:111], v[56:59], v[88:91], v[96:111]
  s_waitcnt lgkmcnt(0)
  v_mfma_f32_32x32x16_bf16 v[96:111], v[60:63], v[92:95], v[96:111]
  s_cmp_eq_u32 s35, 0
  s_cselect_b32 s21, 0xbfb8aa3b, 1.0
  s_nop 15
  v_mul_f32 v96, s21, v96
  v_mul_f32 v97, s21, v97
  v_mul_f32 v98, s21, v98
  v_mul_f32 v99, s21, v99
  v_mul_f32 v100, s21, v100
  v_mul_f32 v101, s21, v101
  v_mul_f32 v102, s21, v102
  v_mul_f32 v103, s21, v103
  v_mul_f32 v104, s21, v104
  v_mul_f32 v105, s21, v105
  v_mul_f32 v106, s21, v106
  v_mul_f32 v107, s21, v107
  v_mul_f32 v108, s21, v108
  v_mul_f32 v109, s21, v109
  v_mul_f32 v110, s21, v110
  v_mul_f32 v111, s21, v111
  v_cvt_pk_bf16_f32 v112, v96, v97
  v_cvt_pk_bf16_f32 v113, v98, v99
  v_cvt_pk_bf16_f32 v114, v100, v101
  v_cvt_pk_bf16_f32 v115, v102, v103
  v_cvt_pk_bf16_f32 v116, v104, v105
  v_cvt_pk_bf16_f32 v117, v106, v107
  v_cvt_pk_bf16_f32 v118, v108, v109
  v_cvt_pk_bf16_f32 v119, v110, v111
  s_mov_b64 exec, s[38:39]
  ds_write_b128 v18, v[112:115]
  ds_write_b128 v19, v[116:119]
  s_mov_b64 exec, -1
  s_branch K1_out
K1_pf:
  v_lshlrev_b32 v3, 7, v2
  s_mul_i32 s22, s20, 20480
  s_waitcnt lgkmcnt(0)
  s_mov_b32 s24, s6
  s_mov_b32 s25, s7
  s_mov_b32 s26, 5120000
  s_mov_b32 s27, 0x00020000
  s_cmp_gt_u32 s20, 8
  s_cbranch_scc1 K1_nowpf
  s_load_dwordx2 s[28:29], s[0:1], 32
  s_load_dwordx4 s[32:35], s[0:1], 48
  s_waitcnt lgkmcnt(0)
  s_cmp_ge_u32 s20, 4
  s_cselect_b32 s28, s34, s28
  s_cselect_b32 s29, s35, s29
  s_cmp_eq_u32 s20, 8
  s_cselect_b32 s28, s32, s28
  s_cselect_b32 s29, s33, s29
  s_cselect_b32 s36, 1, 0
  s_movk_i32 s30, 4096
  s_cmp_eq_u32 s36, 1
  s_cselect_b32 s30, s30, 0x8000
  s_mov_b32 s31, 0x00020000
  s_and_b32 s33, s20, 3
  s_lshl_b32 s33, s33, 13
  buffer_load_dword v7, v3, s[28:31], s33 offen
K1_nowpf:
  s_cmp_ge_u32 s2, 16
  s_cbranch_scc1 K1_nocpf
  s_getpc_b64 s[28:29]
K1_pc:
  s_add_u32 s28, s28, gather_scatter__edge_featured_mpnn_gatedgcn__graph_kernel - K1_pc
  s_addc_u32 s29, s29, 0
  s_mov_b32 s30, K2_codeend - gather_scatter__edge_featured_mpnn_gatedgcn__graph_kernel
  s_mov_b32 s31, 0x00020000
  s_bfe_u32 s33, s2, 0x10003
  s_mul_i32 s33, s33, 16384
  buffer_load_dword v8, v3, s[28:31], s33 offen
  s_add_u32 s33, s33, 8192
  buffer_load_dword v9, v3, s[28:31], s33 offen
K1_nocpf:
  buffer_load_dword v4, v3, s[24:27], s22 offen
  s_add_u32 s22, s22, 8192
  buffer_load_dword v5, v3, s[24:27], s22 offen
  s_add_u32 s22, s22, 8192
  s_mov_b32 exec_hi, 0
  buffer_load_dword v6, v3, s[24:27], s22 offen
  s_endpgm
K1_sort:
  s_setprio 3
  v_mov_b32 v4, 0
  v_mov_b32 v5, 0
  v_mov_b32 v6, 0
  v_mov_b32 v7, 0
  v_lshlrev_b32 v8, 5, v2
  v_add_u32 v9, 77824, v8
  ds_write_b128 v9, v[4:7]
  ds_write_b128 v9, v[4:7] offset:16
  v_lshlrev_b32 v3, 2, v2
  s_mul_i32 s22, s20, 2560
  s_waitcnt lgkmcnt(0)
  s_mov_b32 s24, s10
  s_mov_b32 s25, s11
  s_mov_b32 s26, 640000
  s_mov_b32 s27, 0x00020000
  s_mov_b32 s28, s8
  s_mov_b32 s29, s9
  s_mov_b32 s30, 640000
  s_mov_b32 s31, 0x00020000
  buffer_load_dword v20, v3, s[24:27], s22 offen offset:0
  buffer_load_dword v21, v3, s[24:27], s22 offen offset:256
  buffer_load_dword v22, v3, s[24:27], s22 offen offset:512
  buffer_load_dword v23, v3, s[24:27], s22 offen offset:768
  buffer_load_dword v24, v3, s[24:27], s22 offen offset:1024
  buffer_load_dword v25, v3, s[24:27], s22 offen offset:1280
  buffer_load_dword v26, v3, s[24:27], s22 offen offset:1536
  buffer_load_dword v27, v3, s[24:27], s22 offen offset:1792
  buffer_load_dword v28, v3, s[24:27], s22 offen offset:2048
  buffer_load_dword v29, v3, s[24:27], s22 offen offset:2304
  buffer_load_dword v30, v3, s[28:31], s22 offen offset:0
  buffer_load_dword v31, v3, s[28:31], s22 offen offset:256
  buffer_load_dword v32, v3, s[28:31], s22 offen offset:512
  buffer_load_dword v33, v3, s[28:31], s22 offen offset:768
  buffer_load_dword v34, v3, s[28:31], s22 offen offset:1024
  buffer_load_dword v35, v3, s[28:31], s22 offen offset:1280
  buffer_load_dword v36, v3, s[28:31], s22 offen offset:1536
  buffer_load_dword v37, v3, s[28:31], s22 offen offset:1792
  buffer_load_dword v38, v3, s[28:31], s22 offen offset:2048
  buffer_load_dword v39, v3, s[28:31], s22 offen offset:2304
  v_mov_b32 v5, 1
  s_mov_b32 s21, 0x500000
  v_mov_b32 v61, 77824
  s_waitcnt vmcnt(19)
  v_mul_u32_u24 v40, 52429, v20
  v_lshrrev_b32 v40, 20, v40
  v_mul_u32_u24 v6, 20, v40
  v_sub_u32 v20, v20, v6
  v_lshl_add_u32 v40, v40, 2, v61
  ds_add_rtn_u32 v50, v40, v5
  s_waitcnt vmcnt(18)
  v_mul_u32_u24 v41, 52429, v21
  v_lshrrev_b32 v41, 20, v41
  v_mul_u32_u24 v6, 20, v41
  v_sub_u32 v21, v21, v6
  v_lshl_add_u32 v41, v41, 2, v61
  ds_add_rtn_u32 v51, v41, v5
  s_waitcnt vmcnt(17)
  v_mul_u32_u24 v42, 52429, v22
  v_lshrrev_b32 v42, 20, v42
  v_mul_u32_u24 v6, 20, v42
  v_sub_u32 v22, v22, v6
  v_lshl_add_u32 v42, v42, 2, v61
  ds_add_rtn_u32 v52, v42, v5
  s_waitcnt vmcnt(16)
  v_mul_u32_u24 v43, 52429, v23
  v_lshrrev_b32 v43, 20, v43
  v_mul_u32_u24 v6, 20, v43
  v_sub_u32 v23, v23, v6
  v_lshl_add_u32 v43, v43, 2, v61
  ds_add_rtn_u32 v53, v43, v5
  s_waitcnt vmcnt(15)
  v_mul_u32_u24 v44, 52429, v24
  v_lshrrev_b32 v44, 20, v44
  v_mul_u32_u24 v6, 20, v44
  v_sub_u32 v24, v24, v6
  v_lshl_add_u32 v44, v44, 2, v61
  ds_add_rtn_u32 v54, v44, v5
  s_waitcnt vmcnt(14)
  v_mul_u32_u24 v45, 52429, v25
  v_lshrrev_b32 v45, 20, v45
  v_mul_u32_u24 v6, 20, v45
  v_sub_u32 v25, v25, v6
  v_lshl_add_u32 v45, v45, 2, v61
  ds_add_rtn_u32 v55, v45, v5
  s_waitcnt vmcnt(13)
  v_mul_u32_u24 v46, 52429, v26
  v_lshrrev_b32 v46, 20, v46
  v_mul_u32_u24 v6, 20, v46
  v_sub_u32 v26, v26, v6
  v_lshl_add_u32 v46, v46, 2, v61
  ds_add_rtn_u32 v56, v46, v5
  s_waitcnt vmcnt(12)
  v_mul_u32_u24 v47, 52429, v27
  v_lshrrev_b32 v47, 20, v47
  v_mul_u32_u24 v6, 20, v47
  v_sub_u32 v27, v27, v6
  v_lshl_add_u32 v47, v47, 2, v61
  ds_add_rtn_u32 v57, v47, v5
  s_waitcnt vmcnt(11)
  v_mul_u32_u24 v48, 52429, v28
  v_lshrrev_b32 v48, 20, v48
  v_mul_u32_u24 v6, 20, v48
  v_sub_u32 v28, v28, v6
  v_lshl_add_u32 v48, v48, 2, v61
  ds_add_rtn_u32 v58, v48, v5
  s_waitcnt vmcnt(10)
  v_mul_u32_u24 v49, 52429, v29
  v_lshrrev_b32 v49, 20, v49
  v_mul_u32_u24 v6, 20, v49
  v_sub_u32 v29, v29, v6
  v_lshl_add_u32 v49, v49, 2, v61
  ds_add_rtn_u32 v59, v49, v5
  s_waitcnt vmcnt(0)
  v_lshl_or_b32 v30, v20, 14, v30
  v_add_u32 v6, 0, v2
  v_lshl_or_b32 v30, v6, 19, v30
  v_lshl_or_b32 v31, v21, 14, v31
  v_add_u32 v6, 64, v2
  v_lshl_or_b32 v31, v6, 19, v31
  v_lshl_or_b32 v32, v22, 14, v32
  v_add_u32 v6, 128, v2
  v_lshl_or_b32 v32, v6, 19, v32
  v_lshl_or_b32 v33, v23, 14, v33
  v_add_u32 v6, 192, v2
  v_lshl_or_b32 v33, v6, 19, v33
  v_lshl_or_b32 v34, v24, 14, v34
  v_add_u32 v6, 256, v2
  v_lshl_or_b32 v34, v6, 19, v34
  v_lshl_or_b32 v35, v25, 14, v35
  v_add_u32 v6, 320, v2
  v_lshl_or_b32 v35, v6, 19, v35
  v_lshl_or_b32 v36, v26, 14, v36
  v_add_u32 v6, 384, v2
  v_lshl_or_b32 v36, v6, 19, v36
  v_lshl_or_b32 v37, v27, 14, v37
  v_add_u32 v6, 448, v2
  v_lshl_or_b32 v37, v6, 19, v37
  v_lshl_or_b32 v38, v28, 14, v38
  v_add_u32 v6, 512, v2
  v_lshl_or_b32 v38, v6, 19, v38
  v_lshl_or_b32 v39, v29, 14, v39
  v_add_u32 v6, 576, v2
  v_lshl_or_b32 v39, v6, 19, v39
  s_waitcnt lgkmcnt(0)
  ds_read_b128 v[64:67], v9
  ds_read_b128 v[68:71], v9 offset:16
  s_waitcnt lgkmcnt(0)
  v_mov_b32 v72, 0
  v_mov_b32 v73, v64
  v_add_u32 v74, v73, v65
  v_add_u32 v75, v74, v66
  v_add_u32 v76, v75, v67
  v_add_u32 v77, v76, v68
  v_add_u32 v78, v77, v69
  v_add_u32 v79, v78, v70
  v_add_u32 v80, v79, v71
  v_mov_b32 v81, v80
  s_nop 1
  v_add_u32_dpp v81, v81, v81 row_shr:1 row_mask:0xf bank_mask:0xf bound_ctrl:1
  s_nop 1
  v_add_u32_dpp v81, v81, v81 row_shr:2 row_mask:0xf bank_mask:0xf bound_ctrl:1
  s_nop 1
  v_add_u32_dpp v81, v81, v81 row_shr:4 row_mask:0xf bank_mask:0xf bound_ctrl:1
  s_nop 1
  v_add_u32_dpp v81, v81, v81 row_shr:8 row_mask:0xf bank_mask:0xf bound_ctrl:1
  s_nop 1
  v_add_u32_dpp v81, v81, v81 row_bcast:15 row_mask:0xa bank_mask:0xf
  s_nop 1
  v_add_u32_dpp v81, v81, v81 row_bcast:31 row_mask:0xc bank_mask:0xf
  v_sub_u32 v82, v81, v80
  v_add_u32 v72, v72, v82
  v_add_u32 v73, v73, v82
  v_add_u32 v74, v74, v82
  v_add_u32 v75, v75, v82
  v_add_u32 v76, v76, v82
  v_add_u32 v77, v77, v82
  v_add_u32 v78, v78, v82
  v_add_u32 v79, v79, v82
  ds_write_b128 v9, v[72:75] offset:2048
  ds_write_b128 v9, v[76:79] offset:2064
  s_waitcnt lgkmcnt(0)
  ds_read_b32 v20, v40 offset:2048
  ds_read_b32 v21, v41 offset:2048
  ds_read_b32 v22, v42 offset:2048
  ds_read_b32 v23, v43 offset:2048
  ds_read_b32 v24, v44 offset:2048
  ds_read_b32 v25, v45 offset:2048
  ds_read_b32 v26, v46 offset:2048
  ds_read_b32 v27, v47 offset:2048
  ds_read_b32 v28, v48 offset:2048
  ds_read_b32 v29, v49 offset:2048
  s_barrier
  v_lshl_or_b32 v84, v73, 10, v72
  v_lshl_or_b32 v84, v74, 20, v84
  v_lshl_or_b32 v85, v75, 10, v74
  v_lshl_or_b32 v85, v76, 20, v85
  v_lshl_or_b32 v86, v77, 10, v76
  v_lshl_or_b32 v86, v78, 20, v86
  v_lshl_or_b32 v87, v79, 10, v78
  v_lshl_or_b32 v87, v81, 20, v87
  s_add_u32 s24, s16, 0x640000
  s_addc_u32 s25, s17, 0
  s_mov_b32 s26, 256000
  s_mov_b32 s27, 0x00020000
  v_lshlrev_b32 v88, 12, v2
  s_lshl_b32 s21, s20, 3
  buffer_store_dwordx2 v[84:85], v88, s[24:27], s21 offen
  buffer_store_dwordx2 v[86:87], v88, s[24:27], s21 offen offset:2048
  s_waitcnt lgkmcnt(0)
  v_mov_b32 v62, 81920
  v_add_u32 v20, v20, v50
  v_lshl_add_u32 v40, v20, 2, v62
  ds_write_b32 v40, v30
  v_add_u32 v21, v21, v51
  v_lshl_add_u32 v41, v21, 2, v62
  ds_write_b32 v41, v31
  v_add_u32 v22, v22, v52
  v_lshl_add_u32 v42, v22, 2, v62
  ds_write_b32 v42, v32
  v_add_u32 v23, v23, v53
  v_lshl_add_u32 v43, v23, 2, v62
  ds_write_b32 v43, v33
  v_add_u32 v24, v24, v54
  v_lshl_add_u32 v44, v24, 2, v62
  ds_write_b32 v44, v34
  v_add_u32 v25, v25, v55
  v_lshl_add_u32 v45, v25, 2, v62
  ds_write_b32 v45, v35
  v_add_u32 v26, v26, v56
  v_lshl_add_u32 v46, v26, 2, v62
  ds_write_b32 v46, v36
  v_add_u32 v27, v27, v57
  v_lshl_add_u32 v47, v27, 2, v62
  ds_write_b32 v47, v37
  v_add_u32 v28, v28, v58
  v_lshl_add_u32 v48, v28, 2, v62
  ds_write_b32 v48, v38
  v_add_u32 v29, v29, v59
  v_lshl_add_u32 v49, v29, 2, v62
  ds_write_b32 v49, v39
K1_out:
  s_waitcnt lgkmcnt(0)
  s_barrier
  s_cmp_ge_u32 s3, 10
  s_cbranch_scc1 K1_oute
  v_lshlrev_b32 v3, 4, v2
  s_lshl_b32 s21, s3, 11
  s_add_u32 s21, s21, 57344
  v_add_u32 v3, s21, v3
  ds_read_b128 v[32:35], v3
  ds_read_b128 v[36:39], v3 offset:1024
  s_mul_i32 s21, s19, 2621440
  s_add_u32 s21, s21, 8388608
  s_add_u32 s24, s16, s21
  s_addc_u32 s25, s17, 0
  s_mov_b32 s26, 2560000
  s_mov_b32 s27, 0x00020000
  s_mul_i32 s22, s18, 20480
  s_waitcnt lgkmcnt(1)
  buffer_store_dwordx4 v[32:35], v10, s[24:27], s22 offen sc1
  s_waitcnt lgkmcnt(0)
  buffer_store_dwordx4 v[36:39], v11, s[24:27], s22 offen sc1
  s_branch K1_end
K1_oute:
  s_cmp_lg_u32 s3, 12
  s_cbranch_scc1 K1_end
  v_lshlrev_b32 v3, 4, v2
  s_add_u32 s28, s16, 0x500000
  s_addc_u32 s29, s17, 0
  s_mov_b32 s30, 640000
  s_mov_b32 s31, 0x00020000
  v_add_u32 v4, 81920, v3
  ds_read_b128 v[40:43], v4
  ds_read_b128 v[44:47], v4 offset:1024
  ds_read_b128 v[48:51], v4 offset:2048
  s_mul_i32 s22, s20, 2560
  s_waitcnt lgkmcnt(0)
  buffer_store_dwordx4 v[40:43], v3, s[28:31], s22 offen sc1
  buffer_store_dwordx4 v[44:47], v3, s[28:31], s22 offen offset:1024 sc1
  s_mov_b32 exec_hi, 0
  buffer_store_dwordx4 v[48:51], v3, s[28:31], s22 offen offset:2048 sc1
  s_mov_b32 exec_hi, -1
K1_end:
K1_done:
  s_endpgm
K1_codeend:
.globl gather_scatter__edge_featured_mpnn_gatedgcn__graph_kernel
.p2align 8
.type gather_scatter__edge_featured_mpnn_gatedgcn__graph_kernel,@function
gather_scatter__edge_featured_mpnn_gatedgcn__graph_kernel:
  s_cmp_ge_u32 s2, 256
  s_cbranch_scc1 K2_done
  s_load_dwordx2 s[78:79], s[0:1], 88
  s_load_dwordx2 s[64:65], s[0:1], 0
  s_load_dwordx2 s[44:45], s[0:1], 8
  s_load_dwordx2 s[68:69], s[0:1], 32
  s_load_dwordx4 s[72:75], s[0:1], 48
  s_load_dwordx2 s[76:77], s[0:1], 72
  s_and_b32 s4, s2, 7
  s_lshr_b32 s5, s2, 3
  s_and_b32 s48, s4, 1
  s_lshr_b32 s4, s4, 1
  s_lshl_b32 s4, s4, 5
  s_add_u32 s49, s4, s5
  s_cmp_ge_u32 s49, 125
  s_cbranch_scc1 K2_done
  v_lshrrev_b32 v1, 6, v0
  v_and_b32 v219, 63, v0
  v_readfirstlane_b32 s3, v1
  v_lshlrev_b32 v220, 2, v219
  v_lshlrev_b32 v226, 5, v219
  s_cmp_lg_u32 s3, 7
  s_cbranch_scc1 K2_nospf
  s_getpc_b64 s[20:21]
K2_pc0:
  s_sub_u32 s20, s20, K2_pc0 - gather_scatter__edge_featured_mpnn_gatedgcn__graph_kernel
  s_subb_u32 s21, s21, 0
  s_mov_b32 s22, K2_codeend - gather_scatter__edge_featured_mpnn_gatedgcn__graph_kernel
  s_mov_b32 s23, 0x00020000
  v_lshlrev_b32 v250, 7, v219
  buffer_load_dword v251, v250, s[20:23], 0 offen
  s_movk_i32 s4, 0x2000
  buffer_load_dword v249, v250, s[20:23], s4 offen
K2_nospf:
  s_and_b32 s66, s3, 3
  s_mul_i32 s67, s66, 4864
  s_add_u32 s67, s67, 140288
  s_lshl_b32 s7, s49, 11
  s_lshr_b32 s4, s66, 1
  s_lshl_b32 s4, s4, 2
  s_add_u32 s7, s7, s4
  s_mov_b32 s55, 0
  s_waitcnt lgkmcnt(0)
  s_mov_b32 s8, s64
  s_mov_b32 s9, s65
  s_mov_b32 s10, 2560000
  s_mov_b32 s11, 0x00020000
  s_add_u32 s32, s78, 0x500000
  s_addc_u32 s33, s79, 0
  s_mov_b32 s34, 640000
  s_mov_b32 s35, 0x00020000
  s_cmp_ge_u32 s3, 4
  s_cbranch_scc1 K2_stage
  s_add_u32 s40, s78, 0x640000
  s_addc_u32 s41, s79, 0
  s_mov_b32 s42, 256000
  s_mov_b32 s43, 0x00020000
  buffer_load_dword v236, v226, s[40:43], s7 offen offset:0
  buffer_load_dword v237, v226, s[40:43], s7 offen offset:8
  buffer_load_dword v238, v226, s[40:43], s7 offen offset:16
  buffer_load_dword v239, v226, s[40:43], s7 offen offset:24
  v_add_u32 v228, s67, v220
  v_mov_b32 v229, 0x640ffff
  v_mov_b32 v230, -1
  ds_write_b32 v228, v229 offset:0
  ds_write_b32 v228, v229 offset:256
  ds_write_b32 v228, v229 offset:512
  ds_write_b32 v228, v229 offset:768
  ds_write_b32 v228, v229 offset:1024
  ds_write_b32 v228, v229 offset:1280
  ds_write_b32 v228, v229 offset:1536
  ds_write_b32 v228, v229 offset:1792
  ds_write_b32 v228, v229 offset:2048
  ds_write_b32 v228, v230 offset:4480
  s_mov_b32 exec_hi, 0
  ds_write_b32 v228, v229 offset:2304
  ds_write_b32 v228, v230 offset:4736
  s_mov_b32 exec_hi, -1
  v_mov_b32 v232, 0
  v_mov_b32 v233, 0
  v_mov_b32 v234, 0
  v_mov_b32 v235, 0
  s_lshl_b32 s39, s66, 11
  v_add_u32 v227, s39, v226
  ds_write_b128 v227, v[232:235]
  ds_write_b128 v227, v[232:235] offset:16
  s_lshl_b32 s4, s66, 6
  s_add_u32 s4, s4, 163120
  v_and_b32 v231, 15, v219
  v_lshl_add_u32 v231, v231, 2, s4
  ds_write_b32 v231, v232
  s_movk_i32 s73, 640
  s_movk_i32 s74, 1280
  s_movk_i32 s75, 1920
  s_mov_b32 s12, s44
  s_mov_b32 s13, s45
  s_and_b32 s13, s13, 0xffff
  s_or_b32 s13, s13, 0x200000
  s_mov_b32 s14, 160000
  s_mov_b32 s15, 0x00020000
  s_mov_b32 s44, s76
  s_mov_b32 s45, s77
  s_mov_b32 s46, 2560000
  s_mov_b32 s47, 0x00020000
  s_mul_i32 s4, s48, 2621440
  s_add_u32 s4, s4, 8385536
  s_add_u32 s4, s78, s4
  s_addc_u32 s5, s79, 0
  s_mov_b32 s16, s4
  s_mov_b32 s17, s5
  s_and_b32 s17, s17, 0xffff
  s_or_b32 s17, s17, 0x1000000
  s_mov_b32 s18, 10000
  s_mov_b32 s19, 0x00020000
  s_movk_i32 s36, 3072
  s_movk_i32 s37, 2048
  s_movk_i32 s38, 1024
  s_mul_i32 s58, s3, 10240
  v_lshrrev_b32 v223, 5, v219
  v_and_b32 v224, 31, v219
  v_lshrrev_b32 v32, 4, v219
  v_xor_b32 v33, v32, v219
  v_and_b32 v34, 7, v33
  v_lshlrev_b32 v193, 4, v34
  v_and_b32 v34, 1, v33
  v_lshlrev_b32 v201, 4, v34
  v_lshrrev_b32 v34, 3, v219
  v_lshlrev_b32 v208, 4, v34
  v_bfe_u32 v34, v219, 1, 3
  v_lshl_add_u32 v34, v34, 2, v32
  v_lshlrev_b32 v209, 2, v34
  v_and_b32 v34, 7, v219
  v_bfe_u32 v35, v219, 3, 2
  v_lshl_add_u32 v34, v34, 2, v35
  v_lshlrev_b32 v210, 2, v34
  v_bfe_u32 v34, v219, 2, 2
  v_lshl_add_u32 v35, v223, 2, v34
  v_lshlrev_b32 v211, 4, v35
  v_lshl_add_u32 v221, v223, 3, v34
  v_lshlrev_b32 v221, 7, v221
  v_add_u32 v221, 81920, v221
  v_bfe_u32 v34, v219, 4, 1
  v_lshlrev_b32 v222, 5, v34
  v_and_b32 v34, 3, v219
  v_lshl_add_u32 v222, v34, 3, v222
  v_bfe_u32 v34, v219, 3, 1
  v_lshlrev_b32 v225, 6, v34
  v_add_u32 v218, 161424, v222
  v_lshlrev_b32 v217, 4, v223
  v_add_u32 v217, 159744, v217
  v_bfe_u32 v34, v224, 1, 3
  v_xor_b32 v34, v34, v223
  v_lshlrev_b32 v34, 4, v34
  v_lshl_add_u32 v34, v224, 7, v34
  v_add_u32 v212, s58, v34
  v_xor_b32 v213, 32, v212
  v_xor_b32 v214, 64, v212
  v_xor_b32 v215, 96, v212
  v_bfe_u32 v34, v224, 3, 1
  v_xor_b32 v34, v34, v223
  v_lshlrev_b32 v34, 4, v34
  v_lshl_add_u32 v34, v224, 5, v34
  s_add_u32 s4, s58, 4096
  v_add_u32 v216, s4, v34
  v_and_b32 v34, 1, v224
  v_lshlrev_b32 v34, 4, v34
  v_mov_b32 v35, 0x3f80
  v_lshlrev_b32 v34, v34, v35
  v_lshlrev_b32 v35, 3, v223
  v_sub_u32 v35, v224, v35
  v_ashrrev_i32 v35, 1, v35
  v_cmp_eq_u32 vcc, 0, v35
  v_cmp_eq_u32 s[60:61], 1, v35
  s_nop 0
  v_cndmask_b32 v148, 0, v34, vcc
  v_cndmask_b32 v149, 0, v34, s[60:61]
  v_cmp_eq_u32 vcc, 2, v35
  v_cmp_eq_u32 s[60:61], 3, v35
  s_nop 0
  v_cndmask_b32 v150, 0, v34, vcc
  v_cndmask_b32 v151, 0, v34, s[60:61]
  v_cmp_eq_u32 vcc, 8, v35
  v_cmp_eq_u32 s[60:61], 9, v35
  s_nop 0
  v_cndmask_b32 v152, 0, v34, vcc
  v_cndmask_b32 v153, 0, v34, s[60:61]
  v_cmp_eq_u32 vcc, 10, v35
  v_cmp_eq_u32 s[60:61], 11, v35
  s_nop 0
  v_cndmask_b32 v154, 0, v34, vcc
  v_cndmask_b32 v155, 0, v34, s[60:61]
  v_mov_b32 v36, 0
  v_mov_b32 v37, 0
  v_mov_b32 v38, 0
  v_mov_b32 v39, 0
  s_nop 1
  v_mfma_f32_32x32x16_bf16 v[0:15], v[36:39], v[36:39], 0
  v_mfma_f32_32x32x16_bf16 v[16:31], v[36:39], v[36:39], 0
  v_mfma_f32_32x32x16_bf16 v[96:111], v[36:39], v[36:39], 0
  s_waitcnt vmcnt(0)
  s_and_b32 s4, s66, 1
  s_mul_i32 s4, s4, 10
  s_add_u32 s5, s4, 10
  v_mul_u32_u24 v231, 2560, v219
  v_mov_b32 v240, 0
  v_mov_b32 v241, 0
  v_mov_b32 v242, 0
  v_mov_b32 v243, 0
  s_bitset0_b32 exec_hi, 31
  v_bfe_u32 v244, v236, s4, 10
  v_bfe_u32 v240, v236, s5, 10
  v_sub_u32 v240, v240, v244
  v_bfe_u32 v245, v237, s4, 10
  v_bfe_u32 v241, v237, s5, 10
  v_sub_u32 v241, v241, v245
  s_bitset0_b32 exec_hi, 30
  v_bfe_u32 v246, v238, s4, 10
  v_bfe_u32 v242, v238, s5, 10
  v_sub_u32 v242, v242, v246
  v_bfe_u32 v247, v239, s4, 10
  v_bfe_u32 v243, v239, s5, 10
  v_sub_u32 v243, v243, v247
  s_mov_b64 exec, -1
  v_add3_u32 v244, v244, v231, 0
  v_add3_u32 v245, v245, v231, s73
  v_add3_u32 v246, v246, v231, s74
  v_add3_u32 v247, v247, v231, s75
  v_mov_b32 v248, 0
  v_mov_b32 v249, v240
  v_add_u32 v250, v240, v241
  v_add_u32 v251, v250, v242
  v_add_u32 v232, v251, v243
  v_mov_b32 v233, v232
  s_nop 1
  v_add_u32_dpp v233, v233, v233 row_shr:1 row_mask:0xf bank_mask:0xf bound_ctrl:1
  s_nop 1
  v_add_u32_dpp v233, v233, v233 row_shr:2 row_mask:0xf bank_mask:0xf bound_ctrl:1
  s_nop 1
  v_add_u32_dpp v233, v233, v233 row_shr:4 row_mask:0xf bank_mask:0xf bound_ctrl:1
  s_nop 1
  v_add_u32_dpp v233, v233, v233 row_shr:8 row_mask:0xf bank_mask:0xf bound_ctrl:1
  s_nop 1
  v_add_u32_dpp v233, v233, v233 row_bcast:15 row_mask:0xa bank_mask:0xf
  s_nop 1
  v_add_u32_dpp v233, v233, v233 row_bcast:31 row_mask:0xc bank_mask:0xf
  s_nop 0
  v_readlane_b32 s70, v233, 63
  v_sub_u32 v233, v233, v232
  v_add_u32 v248, v248, v233
  v_add_u32 v249, v249, v233
  v_add_u32 v250, v250, v233
  v_add_u32 v251, v251, v233
  s_lshl_b32 s4, s66, 2
  s_add_u32 s4, s4, 163104
  v_mov_b32 v232, s4
  v_mov_b32 v233, s70
  ds_write_b32 v232, v233
  s_min_u32 s71, s70, 512
  s_cmp_le_u32 s70, 512
  s_cbranch_scc0 K2_slow0
  v_sub_u32 v232, v244, v248
  v_lshl_add_u32 v236, v248, 2, s39
  v_sub_u32 v233, v245, v249
  v_lshl_add_u32 v237, v249, 2, s39
  v_sub_u32 v234, v246, v250
  v_lshl_add_u32 v238, v250, 2, s39
  v_sub_u32 v235, v247, v251
  v_lshl_add_u32 v239, v251, 2, s39
  v_cmpx_lt_u32 vcc, 0, v240
  ds_write_b32 v236, v232
  s_mov_b64 exec, -1
  v_cmpx_lt_u32 vcc, 0, v241
  ds_write_b32 v237, v233
  s_mov_b64 exec, -1
  v_cmpx_lt_u32 vcc, 0, v242
  ds_write_b32 v238, v234
  s_mov_b64 exec, -1
  v_cmpx_lt_u32 vcc, 0, v243
  ds_write_b32 v239, v235
  s_mov_b64 exec, -1
  s_waitcnt lgkmcnt(0)
  ds_read_b128 v[232:235], v227
  ds_read_b128 v[236:239], v227 offset:16
  v_lshlrev_b32 v231, 3, v219
  s_add_u32 s4, s67, 2432
  v_lshl_add_u32 v230, v219, 5, s4
  s_waitcnt lgkmcnt(0)
  v_max_u32 v233, v233, v232
  v_max_u32 v234, v234, v233
  v_max_u32 v235, v235, v234
  v_max_u32 v236, v236, v235
  v_max_u32 v237, v237, v236
  v_max_u32 v238, v238, v237
  v_max_u32 v239, v239, v238
  v_mov_b32 v229, v239
  s_nop 1
  v_max_u32_dpp v229, v229, v229 row_shr:1 row_mask:0xf bank_mask:0xf bound_ctrl:1
  s_nop 1
  v_max_u32_dpp v229, v229, v229 row_shr:2 row_mask:0xf bank_mask:0xf bound_ctrl:1
  s_nop 1
  v_max_u32_dpp v229, v229, v229 row_shr:4 row_mask:0xf bank_mask:0xf bound_ctrl:1
  s_nop 1
  v_max_u32_dpp v229, v229, v229 row_shr:8 row_mask:0xf bank_mask:0xf bound_ctrl:1
  s_nop 1
  v_max_u32_dpp v229, v229, v229 row_bcast:15 row_mask:0xa bank_mask:0xf
  s_nop 1
  v_max_u32_dpp v229, v229, v229 row_bcast:31 row_mask:0xc bank_mask:0xf
  v_mov_b32 v228, 0
  s_nop 0
  v_mov_b32_dpp v228, v229 wave_shr:1 row_mask:0xf bank_mask:0xf
  v_max_u32 v232, v232, v228
  v_add3_u32 v232, v232, v231, 0
  v_max_u32 v233, v233, v228
  v_add3_u32 v233, v233, v231, 1
  v_max_u32 v234, v234, v228
  v_add3_u32 v234, v234, v231, 2
  v_max_u32 v235, v235, v228
  v_add3_u32 v235, v235, v231, 3
  v_max_u32 v236, v236, v228
  v_add3_u32 v236, v236, v231, 4
  v_max_u32 v237, v237, v228
  v_add3_u32 v237, v237, v231, 5
  v_max_u32 v238, v238, v228
  v_add3_u32 v238, v238, v231, 6
  v_max_u32 v239, v239, v228
  v_add3_u32 v239, v239, v231, 7
  ds_write_b128 v230, v[232:235]
  ds_write_b128 v230, v[236:239] offset:16
  v_add_u32 v231, s70, v219
  v_lshl_add_u32 v230, v231, 2, s4
  v_mov_b32 v229, -1
  s_movk_i32 s5, 544
  v_cmp_gt_u32 s[60:61], s5, v231
  s_movk_i32 s5, 608
  v_cmpx_gt_u32 vcc, s5, v231
  ds_write_b32 v230, v229
  s_mov_b64 exec, s[60:61]
  ds_write_b32 v230, v229 offset:256
  s_mov_b64 exec, -1
  v_lshl_add_u32 v231, v219, 2, s67
  s_waitcnt lgkmcnt(0)
  ds_read_b32 v232, v231 offset:2432
  ds_read_b32 v233, v231 offset:2688
  ds_read_b32 v234, v231 offset:2944
  ds_read_b32 v235, v231 offset:3200
  ds_read_b32 v236, v231 offset:3456
  ds_read_b32 v237, v231 offset:3712
  ds_read_b32 v238, v231 offset:3968
  ds_read_b32 v239, v231 offset:4224
  v_mov_b32 v231, v219
  v_cmp_gt_u32 s[20:21], s71, v231
  v_add_u32 v231, 64, v231
  v_cmp_gt_u32 s[22:23], s71, v231
  v_add_u32 v231, 64, v231
  v_cmp_gt_u32 s[24:25], s71, v231
  v_add_u32 v231, 64, v231
  v_cmp_gt_u32 s[26:27], s71, v231
  v_add_u32 v231, 64, v231
  v_cmp_gt_u32 s[28:29], s71, v231
  v_add_u32 v231, 64, v231
  v_cmp_gt_u32 s[30:31], s71, v231
  v_add_u32 v231, 64, v231
  v_cmp_gt_u32 s[64:65], s71, v231
  v_add_u32 v231, 64, v231
  v_cmp_gt_u32 s[68:69], s71, v231
  v_add_u32 v231, 64, v231
  s_waitcnt lgkmcnt(0)
  v_lshlrev_b32 v40, 2, v232
  v_lshlrev_b32 v41, 2, v233
  v_lshlrev_b32 v42, 2, v234
  v_lshlrev_b32 v43, 2, v235
  v_lshlrev_b32 v44, 2, v236
  v_lshlrev_b32 v45, 2, v237
  v_lshlrev_b32 v46, 2, v238
  v_lshlrev_b32 v47, 2, v239
  s_cmp_eq_u64 s[20:21], 0
  s_cbranch_scc1 K2_recldF
  s_mov_b64 exec, s[20:21]
  buffer_load_dword v32, v40, s[32:35], 0 offen
  s_cmp_eq_u64 s[22:23], 0
  s_cbranch_scc1 K2_recldF
  s_mov_b64 exec, s[22:23]
  buffer_load_dword v33, v41, s[32:35], 0 offen
  s_cmp_eq_u64 s[24:25], 0
  s_cbranch_scc1 K2_recldF
  s_mov_b64 exec, s[24:25]
  buffer_load_dword v34, v42, s[32:35], 0 offen
  s_cmp_eq_u64 s[26:27], 0
  s_cbranch_scc1 K2_recldF
  s_mov_b64 exec, s[26:27]
  buffer_load_dword v35, v43, s[32:35], 0 offen
  s_cmp_eq_u64 s[28:29], 0
  s_cbranch_scc1 K2_recldF
  s_mov_b64 exec, s[28:29]
  buffer_load_dword v36, v44, s[32:35], 0 offen
  s_cmp_eq_u64 s[30:31], 0
  s_cbranch_scc1 K2_recldF
  s_mov_b64 exec, s[30:31]
  buffer_load_dword v37, v45, s[32:35], 0 offen
  s_cmp_eq_u64 s[64:65], 0
  s_cbranch_scc1 K2_recldF
  s_mov_b64 exec, s[64:65]
  buffer_load_dword v38, v46, s[32:35], 0 offen
  s_cmp_eq_u64 s[68:69], 0
  s_cbranch_scc1 K2_recldF
  s_mov_b64 exec, s[68:69]
  buffer_load_dword v39, v47, s[32:35], 0 offen
K2_recldF:
  s_mov_b64 exec, -1
  s_branch K2_b1
K2_slow0:
  v_lshl_add_u32 v228, v219, 2, s67
  v_mov_b32 v230, -1
  ds_write_b32 v228, v230 offset:2432
  ds_write_b32 v228, v230 offset:2688
  ds_write_b32 v228, v230 offset:2944
  ds_write_b32 v228, v230 offset:3200
  ds_write_b32 v228, v230 offset:3456
  ds_write_b32 v228, v230 offset:3712
  ds_write_b32 v228, v230 offset:3968
  ds_write_b32 v228, v230 offset:4224
  v_sub_u32 v227, s55, v248
  v_max_i32 v227, 0, v227
  v_add_u32 v231, v248, v227
  v_subrev_u32 v231, s55, v231
  v_add_u32 v232, v244, v227
  s_add_u32 s4, s67, 2432
  s_movk_i32 s5, 512
K2_genloop00:
  v_cmp_lt_u32 vcc, v227, v240
  v_cmp_gt_u32 s[60:61], s5, v231
  s_nop 3
  s_and_b64 exec, vcc, s[60:61]
  s_cbranch_execz K2_gendone00
  v_lshl_add_u32 v233, v231, 2, s4
  ds_write_b32 v233, v232
  v_add_u32 v227, 1, v227
  v_add_u32 v231, 1, v231
  v_add_u32 v232, 1, v232
  s_mov_b64 exec, -1
  s_branch K2_genloop00
K2_gendone00:
  s_mov_b64 exec, -1
  v_sub_u32 v227, s55, v249
  v_max_i32 v227, 0, v227
  v_add_u32 v231, v249, v227
  v_subrev_u32 v231, s55, v231
  v_add_u32 v232, v245, v227
  s_add_u32 s4, s67, 2432
  s_movk_i32 s5, 512
K2_genloop01:
  v_cmp_lt_u32 vcc, v227, v241
  v_cmp_gt_u32 s[60:61], s5, v231
  s_nop 3
  s_and_b64 exec, vcc, s[60:61]
  s_cbranch_execz K2_gendone01
  v_lshl_add_u32 v233, v231, 2, s4
  ds_write_b32 v233, v232
  v_add_u32 v227, 1, v227
  v_add_u32 v231, 1, v231
  v_add_u32 v232, 1, v232
  s_mov_b64 exec, -1
  s_branch K2_genloop01
K2_gendone01:
  s_mov_b64 exec, -1
  v_sub_u32 v227, s55, v250
  v_max_i32 v227, 0, v227
  v_add_u32 v231, v250, v227
  v_subrev_u32 v231, s55, v231
  v_add_u32 v232, v246, v227
  s_add_u32 s4, s67, 2432
  s_movk_i32 s5, 512
K2_genloop02:
  v_cmp_lt_u32 vcc, v227, v242
  v_cmp_gt_u32 s[60:61], s5, v231
  s_nop 3
  s_and_b64 exec, vcc, s[60:61]
  s_cbranch_execz K2_gendone02
  v_lshl_add_u32 v233, v231, 2, s4
  ds_write_b32 v233, v232
  v_add_u32 v227, 1, v227
  v_add_u32 v231, 1, v231
  v_add_u32 v232, 1, v232
  s_mov_b64 exec, -1
  s_branch K2_genloop02
K2_gendone02:
  s_mov_b64 exec, -1
  v_sub_u32 v227, s55, v251
  v_max_i32 v227, 0, v227
  v_add_u32 v231, v251, v227
  v_subrev_u32 v231, s55, v231
  v_add_u32 v232, v247, v227
  s_add_u32 s4, s67, 2432
  s_movk_i32 s5, 512
K2_genloop03:
  v_cmp_lt_u32 vcc, v227, v243
  v_cmp_gt_u32 s[60:61], s5, v231
  s_nop 3
  s_and_b64 exec, vcc, s[60:61]
  s_cbranch_execz K2_gendone03
  v_lshl_add_u32 v233, v231, 2, s4
  ds_write_b32 v233, v232
  v_add_u32 v227, 1, v227
  v_add_u32 v231, 1, v231
  v_add_u32 v232, 1, v232
  s_mov_b64 exec, -1
  s_branch K2_genloop03
K2_gendone03:
  s_mov_b64 exec, -1
  v_lshl_add_u32 v231, v219, 2, s67
  s_waitcnt lgkmcnt(0)
  ds_read_b32 v232, v231 offset:2432
  ds_read_b32 v233, v231 offset:2688
  ds_read_b32 v234, v231 offset:2944
  ds_read_b32 v235, v231 offset:3200
  ds_read_b32 v236, v231 offset:3456
  ds_read_b32 v237, v231 offset:3712
  ds_read_b32 v238, v231 offset:3968
  ds_read_b32 v239, v231 offset:4224
  v_mov_b32 v231, v219
  v_cmp_gt_u32 s[20:21], s71, v231
  v_add_u32 v231, 64, v231
  v_cmp_gt_u32 s[22:23], s71, v231
  v_add_u32 v231, 64, v231
  v_cmp_gt_u32 s[24:25], s71, v231
  v_add_u32 v231, 64, v231
  v_cmp_gt_u32 s[26:27], s71, v231
  v_add_u32 v231, 64, v231
  v_cmp_gt_u32 s[28:29], s71, v231
  v_add_u32 v231, 64, v231
  v_cmp_gt_u32 s[30:31], s71, v231
  v_add_u32 v231, 64, v231
  v_cmp_gt_u32 s[64:65], s71, v231
  v_add_u32 v231, 64, v231
  v_cmp_gt_u32 s[68:69], s71, v231
  v_add_u32 v231, 64, v231
  s_waitcnt lgkmcnt(0)
  v_lshlrev_b32 v40, 2, v232
  v_lshlrev_b32 v41, 2, v233
  v_lshlrev_b32 v42, 2, v234
  v_lshlrev_b32 v43, 2, v235
  v_lshlrev_b32 v44, 2, v236
  v_lshlrev_b32 v45, 2, v237
  v_lshlrev_b32 v46, 2, v238
  v_lshlrev_b32 v47, 2, v239
  s_cmp_eq_u64 s[20:21], 0
  s_cbranch_scc1 K2_recldS
  s_mov_b64 exec, s[20:21]
  buffer_load_dword v32, v40, s[32:35], 0 offen
  s_cmp_eq_u64 s[22:23], 0
  s_cbranch_scc1 K2_recldS
  s_mov_b64 exec, s[22:23]
  buffer_load_dword v33, v41, s[32:35], 0 offen
  s_cmp_eq_u64 s[24:25], 0
  s_cbranch_scc1 K2_recldS
  s_mov_b64 exec, s[24:25]
  buffer_load_dword v34, v42, s[32:35], 0 offen
  s_cmp_eq_u64 s[26:27], 0
  s_cbranch_scc1 K2_recldS
  s_mov_b64 exec, s[26:27]
  buffer_load_dword v35, v43, s[32:35], 0 offen
  s_cmp_eq_u64 s[28:29], 0
  s_cbranch_scc1 K2_recldS
  s_mov_b64 exec, s[28:29]
  buffer_load_dword v36, v44, s[32:35], 0 offen
  s_cmp_eq_u64 s[30:31], 0
  s_cbranch_scc1 K2_recldS
  s_mov_b64 exec, s[30:31]
  buffer_load_dword v37, v45, s[32:35], 0 offen
  s_cmp_eq_u64 s[64:65], 0
  s_cbranch_scc1 K2_recldS
  s_mov_b64 exec, s[64:65]
  buffer_load_dword v38, v46, s[32:35], 0 offen
  s_cmp_eq_u64 s[68:69], 0
  s_cbranch_scc1 K2_recldS
  s_mov_b64 exec, s[68:69]
  buffer_load_dword v39, v47, s[32:35], 0 offen
K2_recldS:
  s_mov_b64 exec, -1
  s_branch K2_b1
K2_stage:
  v_lshrrev_b32 v221, 3, v219
  v_bfe_u32 v222, v219, 4, 1
  v_lshlrev_b32 v222, 2, v222
  v_and_b32 v223, 7, v219
  v_xor_b32 v222, v222, v223
  v_lshlrev_b32 v221, 8, v221
  v_lshl_add_u32 v221, v222, 4, v221
  v_lshrrev_b32 v224, 4, v219
  s_lshl_b32 s6, s66, 2
  v_add_u32 v224, s6, v224
  v_xor_b32 v225, v224, v219
  v_and_b32 v225, 15, v225
  v_lshlrev_b32 v225, 4, v225
  v_lshl_add_u32 v225, v224, 8, v225
  s_mul_i32 s5, s49, 20480
  s_lshl_b32 s6, s6, 8
  s_add_u32 m0, s6, 116736
  s_nop 0
  buffer_load_dwordx4 v225, s[8:11], s5 offen lds
  s_add_u32 m0, s6, 120832
  s_add_u32 s5, s5, 4096
  buffer_load_dwordx4 v225, s[8:11], s5 offen lds
  s_add_u32 m0, s6, 124928
  s_add_u32 s5, s5, 4096
  buffer_load_dwordx4 v225, s[8:11], s5 offen lds
  s_add_u32 m0, s6, 129024
  s_add_u32 s5, s5, 4096
  buffer_load_dwordx4 v225, s[8:11], s5 offen lds
  s_add_u32 m0, s6, 133120
  s_add_u32 s5, s5, 4096
  buffer_load_dwordx4 v225, s[8:11], s5 offen lds
  s_cmp_eq_u32 s66, 3
  s_cbranch_scc1 K2_nox5
  s_add_u32 m0, s6, 137216
  s_add_u32 s5, s5, 4096
  buffer_load_dwordx4 v225, s[8:11], s5 offen lds
K2_nox5:
  s_mov_b32 s20, s68
  s_mov_b32 s21, s69
  s_mov_b32 s22, 32768
  s_mov_b32 s23, 0x00020000
  s_mov_b32 s24, s74
  s_mov_b32 s25, s75
  s_mov_b32 s26, 32768
  s_mov_b32 s27, 0x00020000
  s_lshl_b32 s4, s48, 7
  s_lshl_b32 s5, s66, 13
  s_add_u32 s5, s5, s4
  s_lshl_b32 s6, s66, 12
  s_add_u32 m0, s6, 81920
  s_add_u32 s7, s5, 0
  buffer_load_dwordx4 v221, s[20:23], s7 offen lds
  s_add_u32 m0, s6, 82944
  s_add_u32 s7, s5, 2048
  buffer_load_dwordx4 v221, s[20:23], s7 offen lds
  s_add_u32 m0, s6, 83968
  s_add_u32 s7, s5, 4096
  buffer_load_dwordx4 v221, s[20:23], s7 offen lds
  s_add_u32 m0, s6, 84992
  s_add_u32 s7, s5, 6144
  buffer_load_dwordx4 v221, s[20:23], s7 offen lds
  s_add_u32 m0, s6, 98304
  s_add_u32 s7, s5, 0
  buffer_load_dwordx4 v221, s[24:27], s7 offen lds
  s_add_u32 m0, s6, 99328
  s_add_u32 s7, s5, 2048
  buffer_load_dwordx4 v221, s[24:27], s7 offen lds
  s_add_u32 m0, s6, 100352
  s_add_u32 s7, s5, 4096
  buffer_load_dwordx4 v221, s[24:27], s7 offen lds
  s_add_u32 m0, s6, 101376
  s_add_u32 s7, s5, 6144
  buffer_load_dwordx4 v221, s[24:27], s7 offen lds
  s_cmp_ge_u32 s66, 2
  s_cbranch_scc1 K2_nowc
  s_mov_b32 s28, s72
  s_mov_b32 s29, s73
  s_mov_b32 s30, 4096
  s_mov_b32 s31, 0x00020000
  s_lshl_b32 s5, s66, 11
  s_add_u32 s5, s5, s4
  s_lshl_b32 s6, s66, 10
  s_add_u32 m0, s6, 114688
  s_nop 0
  buffer_load_dwordx4 v221, s[28:31], s5 offen lds
K2_nowc:
  s_cmp_lg_u32 s66, 3
  s_cbranch_scc1 K2_nolut
  v_mov_b32 v230, 0
  v_mov_b32 v231, 0
  v_lshlrev_b32 v233, 3, v219
  v_add_u32 v233, 159744, v233
  ds_write_b64 v233, v[230:231] offset:0
  ds_write_b64 v233, v[230:231] offset:512
  ds_write_b64 v233, v[230:231] offset:1024
  ds_write_b64 v233, v[230:231] offset:1536
  ds_write_b64 v233, v[230:231] offset:2048
  ds_write_b64 v233, v[230:231] offset:2560
  v_cmp_gt_u32 vcc, 36, v219
  s_and_saveexec_b64 s[60:61], vcc
  ds_write_b64 v233, v[230:231] offset:3072
  s_mov_b64 exec, 0xfffff
  v_mul_u32_u24 v232, 80, v219
  v_and_b32 v233, 19, v219
  v_bfe_u32 v234, v219, 2, 1
  v_lshl_add_u32 v233, v234, 3, v233
  v_bfe_u32 v234, v219, 3, 1
  v_lshl_add_u32 v233, v234, 2, v233
  v_lshl_add_u32 v233, v233, 1, v232
  v_lshl_add_u32 v234, v219, 1, v232
  v_mov_b32 v235, 0x3f80
  v_add_u32 v233, 159744, v233
  v_add_u32 v234, 161424, v234
  s_waitcnt lgkmcnt(0)
  ds_write_b16 v233, v235
  ds_write_b16 v234, v235
  s_mov_b64 exec, s[60:61]
K2_nolut:
  s_mov_b32 s12, s44
  s_mov_b32 s13, s45
  s_and_b32 s13, s13, 0xffff
  s_or_b32 s13, s13, 0x200000
  s_mov_b32 s14, 160000
  s_mov_b32 s15, 0x00020000
  s_mov_b32 s44, s76
  s_mov_b32 s45, s77
  s_mov_b32 s46, 2560000
  s_mov_b32 s47, 0x00020000
  s_mul_i32 s4, s48, 2621440
  s_add_u32 s4, s4, 8385536
  s_add_u32 s4, s78, s4
  s_addc_u32 s5, s79, 0
  s_mov_b32 s16, s4
  s_mov_b32 s17, s5
  s_and_b32 s17, s17, 0xffff
  s_or_b32 s17, s17, 0x1000000
  s_mov_b32 s18, 10000
  s_mov_b32 s19, 0x00020000
  s_movk_i32 s36, 3072
  s_movk_i32 s37, 2048
  s_movk_i32 s38, 1024
  s_mul_i32 s58, s3, 10240
  v_lshrrev_b32 v223, 5, v219
  v_and_b32 v224, 31, v219
  v_lshrrev_b32 v32, 4, v219
  v_xor_b32 v33, v32, v219
  v_and_b32 v34, 7, v33
  v_lshlrev_b32 v193, 4, v34
  v_and_b32 v34, 1, v33
  v_lshlrev_b32 v201, 4, v34
  v_lshrrev_b32 v34, 3, v219
  v_lshlrev_b32 v208, 4, v34
  v_bfe_u32 v34, v219, 1, 3
  v_lshl_add_u32 v34, v34, 2, v32
  v_lshlrev_b32 v209, 2, v34
  v_and_b32 v34, 7, v219
  v_bfe_u32 v35, v219, 3, 2
  v_lshl_add_u32 v34, v34, 2, v35
  v_lshlrev_b32 v210, 2, v34
  v_bfe_u32 v34, v219, 2, 2
  v_lshl_add_u32 v35, v223, 2, v34
  v_lshlrev_b32 v211, 4, v35
  v_lshl_add_u32 v221, v223, 3, v34
  v_lshlrev_b32 v221, 7, v221
  v_add_u32 v221, 81920, v221
  v_bfe_u32 v34, v219, 4, 1
  v_lshlrev_b32 v222, 5, v34
  v_and_b32 v34, 3, v219
  v_lshl_add_u32 v222, v34, 3, v222
  v_bfe_u32 v34, v219, 3, 1
  v_lshlrev_b32 v225, 6, v34
  v_add_u32 v218, 161424, v222
  v_lshlrev_b32 v217, 4, v223
  v_add_u32 v217, 159744, v217
  v_bfe_u32 v34, v224, 1, 3
  v_xor_b32 v34, v34, v223
  v_lshlrev_b32 v34, 4, v34
  v_lshl_add_u32 v34, v224, 7, v34
  v_add_u32 v212, s58, v34
  v_xor_b32 v213, 32, v212
  v_xor_b32 v214, 64, v212
  v_xor_b32 v215, 96, v212
  v_bfe_u32 v34, v224, 3, 1
  v_xor_b32 v34, v34, v223
  v_lshlrev_b32 v34, 4, v34
  v_lshl_add_u32 v34, v224, 5, v34
  s_add_u32 s4, s58, 4096
  v_add_u32 v216, s4, v34
  v_and_b32 v34, 1, v224
  v_lshlrev_b32 v34, 4, v34
  v_mov_b32 v35, 0x3f80
  v_lshlrev_b32 v34, v34, v35
  v_lshlrev_b32 v35, 3, v223
  v_sub_u32 v35, v224, v35
  v_ashrrev_i32 v35, 1, v35
  v_cmp_eq_u32 vcc, 0, v35
  v_cmp_eq_u32 s[60:61], 1, v35
  s_nop 0
  v_cndmask_b32 v148, 0, v34, vcc
  v_cndmask_b32 v149, 0, v34, s[60:61]
  v_cmp_eq_u32 vcc, 2, v35
  v_cmp_eq_u32 s[60:61], 3, v35
  s_nop 0
  v_cndmask_b32 v150, 0, v34, vcc
  v_cndmask_b32 v151, 0, v34, s[60:61]
  v_cmp_eq_u32 vcc, 8, v35
  v_cmp_eq_u32 s[60:61], 9, v35
  s_nop 0
  v_cndmask_b32 v152, 0, v34, vcc
  v_cndmask_b32 v153, 0, v34, s[60:61]
  v_cmp_eq_u32 vcc, 10, v35
  v_cmp_eq_u32 s[60:61], 11, v35
  s_nop 0
  v_cndmask_b32 v154, 0, v34, vcc
  v_cndmask_b32 v155, 0, v34, s[60:61]
  v_mov_b32 v36, 0
  v_mov_b32 v37, 0
  v_mov_b32 v38, 0
  v_mov_b32 v39, 0
  s_nop 1
  v_mfma_f32_32x32x16_bf16 v[0:15], v[36:39], v[36:39], 0
  v_mfma_f32_32x32x16_bf16 v[16:31], v[36:39], v[36:39], 0
  v_mfma_f32_32x32x16_bf16 v[96:111], v[36:39], v[36:39], 0
  s_waitcnt vmcnt(0)
K2_b1:
  s_waitcnt lgkmcnt(0)
  s_barrier
  v_mov_b32 v72, 163104
  ds_read_b128 v[76:79], v72
  s_waitcnt lgkmcnt(0)
  v_readfirstlane_b32 s4, v76
  v_readfirstlane_b32 s5, v77
  v_readfirstlane_b32 s6, v78
  v_readfirstlane_b32 s7, v79
  s_nop 3
  s_lshl_b32 s4, s4, 2
  s_lshl_b32 s5, s5, 2
  s_or_b32 s5, s5, 1
  s_lshl_b32 s6, s6, 2
  s_or_b32 s6, s6, 2
  s_lshl_b32 s7, s7, 2
  s_or_b32 s7, s7, 3
  s_max_u32 s60, s4, s5
  s_min_u32 s61, s4, s5
  s_max_u32 s4, s6, s7
  s_min_u32 s5, s6, s7
  s_max_u32 s6, s60, s4
  s_min_u32 s4, s60, s4
  s_min_u32 s7, s61, s5
  s_max_u32 s5, s61, s5
  s_max_u32 s60, s4, s5
  s_min_u32 s61, s4, s5
  s_lshr_b32 s56, s6, 2
  s_cmp_ge_u32 s3, 4
  s_cselect_b32 s4, s7, s6
  s_cselect_b32 s5, s61, s60
  s_bitcmp1_b32 s3, 1
  s_cselect_b32 s4, s5, s4
  s_and_b32 s50, s4, 3
  s_lshr_b32 s54, s4, 2
  s_lshr_b32 s4, s3, 2
  s_xor_b32 s51, s3, s4
  s_and_b32 s51, s51, 1
  s_min_u32 s59, s54, 512
  s_mul_i32 s62, s50, 4864
  s_add_u32 s62, s62, 140288
  s_lshl_b32 s4, s51, 7
  s_add_u32 s5, s62, 2432
  v_add_u32 v208, s62, v208
  v_add_u32 v209, s5, v209
  v_add_u32 v210, s62, v210
  v_add_u32 v193, s4, v193
  v_add_u32 v211, s62, v211
  v_xor_b32 v195, 64, v193
  v_mov_b32 v197, v193
  v_mov_b32 v199, v195
  s_cmp_ge_u32 s3, 4
  s_cbranch_scc1 K2_late
  s_cmp_le_u32 s70, 512
  s_cbranch_scc0 K2_nobin
  s_lshl_b32 s4, s66, 6
  s_add_u32 s4, s4, 163120
  v_mov_b32 v231, 1
  s_waitcnt vmcnt(0)
  s_mov_b32 s5, 0x500000
  s_mov_b32 s6, 6710887
  s_movk_i32 s7, 640
  s_cmp_eq_u64 s[20:21], 0
  s_cbranch_scc1 K2_unpB
  v_mul_hi_u32 v232, v232, s6
  v_lshrrev_b32 v230, 19, v32
  v_mad_u32_u24 v232, v232, s7, v230
  v_bfe_u32 v230, v32, 14, 5
  v_and_b32 v32, 0x3fff, v32
  v_mad_u32_u24 v32, v230, s5, v32
  s_cmp_eq_u64 s[22:23], 0
  s_cbranch_scc1 K2_unpB
  v_mul_hi_u32 v233, v233, s6
  v_lshrrev_b32 v230, 19, v33
  v_mad_u32_u24 v233, v233, s7, v230
  v_bfe_u32 v230, v33, 14, 5
  v_and_b32 v33, 0x3fff, v33
  v_mad_u32_u24 v33, v230, s5, v33
  s_cmp_eq_u64 s[24:25], 0
  s_cbranch_scc1 K2_unpB
  v_mul_hi_u32 v234, v234, s6
  v_lshrrev_b32 v230, 19, v34
  v_mad_u32_u24 v234, v234, s7, v230
  v_bfe_u32 v230, v34, 14, 5
  v_and_b32 v34, 0x3fff, v34
  v_mad_u32_u24 v34, v230, s5, v34
  s_cmp_eq_u64 s[26:27], 0
  s_cbranch_scc1 K2_unpB
  v_mul_hi_u32 v235, v235, s6
  v_lshrrev_b32 v230, 19, v35
  v_mad_u32_u24 v235, v235, s7, v230
  v_bfe_u32 v230, v35, 14, 5
  v_and_b32 v35, 0x3fff, v35
  v_mad_u32_u24 v35, v230, s5, v35
  s_cmp_eq_u64 s[28:29], 0
  s_cbranch_scc1 K2_unpB
  v_mul_hi_u32 v236, v236, s6
  v_lshrrev_b32 v230, 19, v36
  v_mad_u32_u24 v236, v236, s7, v230
  v_bfe_u32 v230, v36, 14, 5
  v_and_b32 v36, 0x3fff, v36
  v_mad_u32_u24 v36, v230, s5, v36
  s_cmp_eq_u64 s[30:31], 0
  s_cbranch_scc1 K2_unpB
  v_mul_hi_u32 v237, v237, s6
  v_lshrrev_b32 v230, 19, v37
  v_mad_u32_u24 v237, v237, s7, v230
  v_bfe_u32 v230, v37, 14, 5
  v_and_b32 v37, 0x3fff, v37
  v_mad_u32_u24 v37, v230, s5, v37
  s_cmp_eq_u64 s[64:65], 0
  s_cbranch_scc1 K2_unpB
  v_mul_hi_u32 v238, v238, s6
  v_lshrrev_b32 v230, 19, v38
  v_mad_u32_u24 v238, v238, s7, v230
  v_bfe_u32 v230, v38, 14, 5
  v_and_b32 v38, 0x3fff, v38
  v_mad_u32_u24 v38, v230, s5, v38
  s_cmp_eq_u64 s[68:69], 0
  s_cbranch_scc1 K2_unpB
  v_mul_hi_u32 v239, v239, s6
  v_lshrrev_b32 v230, 19, v39
  v_mad_u32_u24 v239, v239, s7, v230
  v_bfe_u32 v230, v39, 14, 5
  v_and_b32 v39, 0x3fff, v39
  v_mad_u32_u24 v39, v230, s5, v39
K2_unpB:
  s_cmp_eq_u64 s[20:21], 0
  s_cbranch_scc1 K2_binA
  s_mov_b64 exec, s[20:21]
  v_bfe_u32 v40, v32, 10, 4
  v_lshl_add_u32 v40, v40, 2, s4
  ds_add_rtn_u32 v64, v40, v231
  s_cmp_eq_u64 s[22:23], 0
  s_cbranch_scc1 K2_binA
  s_mov_b64 exec, s[22:23]
  v_bfe_u32 v41, v33, 10, 4
  v_lshl_add_u32 v41, v41, 2, s4
  ds_add_rtn_u32 v65, v41, v231
  s_cmp_eq_u64 s[24:25], 0
  s_cbranch_scc1 K2_binA
  s_mov_b64 exec, s[24:25]
  v_bfe_u32 v42, v34, 10, 4
  v_lshl_add_u32 v42, v42, 2, s4
  ds_add_rtn_u32 v66, v42, v231
  s_cmp_eq_u64 s[26:27], 0
  s_cbranch_scc1 K2_binA
  s_mov_b64 exec, s[26:27]
  v_bfe_u32 v43, v35, 10, 4
  v_lshl_add_u32 v43, v43, 2, s4
  ds_add_rtn_u32 v67, v43, v231
  s_cmp_eq_u64 s[28:29], 0
  s_cbranch_scc1 K2_binA
  s_mov_b64 exec, s[28:29]
  v_bfe_u32 v44, v36, 10, 4
  v_lshl_add_u32 v44, v44, 2, s4
  ds_add_rtn_u32 v68, v44, v231
  s_cmp_eq_u64 s[30:31], 0
  s_cbranch_scc1 K2_binA
  s_mov_b64 exec, s[30:31]
  v_bfe_u32 v45, v37, 10, 4
  v_lshl_add_u32 v45, v45, 2, s4
  ds_add_rtn_u32 v69, v45, v231
  s_cmp_eq_u64 s[64:65], 0
  s_cbranch_scc1 K2_binA
  s_mov_b64 exec, s[64:65]
  v_bfe_u32 v46, v38, 10, 4
  v_lshl_add_u32 v46, v46, 2, s4
  ds_add_rtn_u32 v70, v46, v231
  s_cmp_eq_u64 s[68:69], 0
  s_cbranch_scc1 K2_binA
  s_mov_b64 exec, s[68:69]
  v_bfe_u32 v47, v39, 10, 4
  v_lshl_add_u32 v47, v47, 2, s4
  ds_add_rtn_u32 v71, v47, v231
K2_binA:
  s_mov_b64 exec, -1
  v_and_b32 v230, 15, v219
  v_lshl_add_u32 v230, v230, 2, s4
  s_waitcnt lgkmcnt(0)
  ds_read_b32 v229, v230
  s_waitcnt lgkmcnt(0)
  v_mov_b32 v228, v229
  s_nop 1
  v_add_u32_dpp v228, v228, v228 row_shr:1 row_mask:0xf bank_mask:0xf bound_ctrl:1
  s_nop 1
  v_add_u32_dpp v228, v228, v228 row_shr:2 row_mask:0xf bank_mask:0xf bound_ctrl:1
  s_nop 1
  v_add_u32_dpp v228, v228, v228 row_shr:4 row_mask:0xf bank_mask:0xf bound_ctrl:1
  s_nop 1
  v_add_u32_dpp v228, v228, v228 row_shr:8 row_mask:0xf bank_mask:0xf bound_ctrl:1
  v_sub_u32 v228, v228, v229
  ds_write_b32 v230, v228
  s_waitcnt lgkmcnt(0)
  s_cmp_eq_u64 s[20:21], 0
  s_cbranch_scc1 K2_binB
  s_mov_b64 exec, s[20:21]
  ds_read_b32 v40, v40
  s_cmp_eq_u64 s[22:23], 0
  s_cbranch_scc1 K2_binB
  s_mov_b64 exec, s[22:23]
  ds_read_b32 v41, v41
  s_cmp_eq_u64 s[24:25], 0
  s_cbranch_scc1 K2_binB
  s_mov_b64 exec, s[24:25]
  ds_read_b32 v42, v42
  s_cmp_eq_u64 s[26:27], 0
  s_cbranch_scc1 K2_binB
  s_mov_b64 exec, s[26:27]
  ds_read_b32 v43, v43
  s_cmp_eq_u64 s[28:29], 0
  s_cbranch_scc1 K2_binB
  s_mov_b64 exec, s[28:29]
  ds_read_b32 v44, v44
  s_cmp_eq_u64 s[30:31], 0
  s_cbranch_scc1 K2_binB
  s_mov_b64 exec, s[30:31]
  ds_read_b32 v45, v45
  s_cmp_eq_u64 s[64:65], 0
  s_cbranch_scc1 K2_binB
  s_mov_b64 exec, s[64:65]
  ds_read_b32 v46, v46
  s_cmp_eq_u64 s[68:69], 0
  s_cbranch_scc1 K2_binB
  s_mov_b64 exec, s[68:69]
  ds_read_b32 v47, v47
K2_binB:
  s_waitcnt lgkmcnt(0)
  s_cmp_eq_u64 s[20:21], 0
  s_cbranch_scc1 K2_binC
  s_mov_b64 exec, s[20:21]
  v_add_u32 v40, v40, v64
  v_lshl_add_u32 v40, v40, 2, s67
  ds_write_b32 v40, v32
  ds_write_b32 v40, v232 offset:2432
  s_cmp_eq_u64 s[22:23], 0
  s_cbranch_scc1 K2_binC
  s_mov_b64 exec, s[22:23]
  v_add_u32 v41, v41, v65
  v_lshl_add_u32 v41, v41, 2, s67
  ds_write_b32 v41, v33
  ds_write_b32 v41, v233 offset:2432
  s_cmp_eq_u64 s[24:25], 0
  s_cbranch_scc1 K2_binC
  s_mov_b64 exec, s[24:25]
  v_add_u32 v42, v42, v66
  v_lshl_add_u32 v42, v42, 2, s67
  ds_write_b32 v42, v34
  ds_write_b32 v42, v234 offset:2432
  s_cmp_eq_u64 s[26:27], 0
  s_cbranch_scc1 K2_binC
  s_mov_b64 exec, s[26:27]
  v_add_u32 v43, v43, v67
  v_lshl_add_u32 v43, v43, 2, s67
  ds_write_b32 v43, v35
  ds_write_b32 v43, v235 offset:2432
  s_cmp_eq_u64 s[28:29], 0
  s_cbranch_scc1 K2_binC
  s_mov_b64 exec, s[28:29]
  v_add_u32 v44, v44, v68
  v_lshl_add_u32 v44, v44, 2, s67
  ds_write_b32 v44, v36
  ds_write_b32 v44, v236 offset:2432
  s_cmp_eq_u64 s[30:31], 0
  s_cbranch_scc1 K2_binC
  s_mov_b64 exec, s[30:31]
  v_add_u32 v45, v45, v69
  v_lshl_add_u32 v45, v45, 2, s67
  ds_write_b32 v45, v37
  ds_write_b32 v45, v237 offset:2432
  s_cmp_eq_u64 s[64:65], 0
  s_cbranch_scc1 K2_binC
  s_mov_b64 exec, s[64:65]
  v_add_u32 v46, v46, v70
  v_lshl_add_u32 v46, v46, 2, s67
  ds_write_b32 v46, v38
  ds_write_b32 v46, v238 offset:2432
  s_cmp_eq_u64 s[68:69], 0
  s_cbranch_scc1 K2_binC
  s_mov_b64 exec, s[68:69]
  v_add_u32 v47, v47, v71
  v_lshl_add_u32 v47, v47, 2, s67
  ds_write_b32 v47, v39
  ds_write_b32 v47, v239 offset:2432
K2_binC:
  s_mov_b64 exec, -1
  s_branch K2_binned
K2_nobin:
  s_waitcnt vmcnt(0)
  s_mov_b32 s5, 0x500000
  s_mov_b32 s6, 6710887
  s_movk_i32 s7, 640
  s_cmp_eq_u64 s[20:21], 0
  s_cbranch_scc1 K2_unpS
  v_mul_hi_u32 v232, v232, s6
  v_lshrrev_b32 v230, 19, v32
  v_mad_u32_u24 v232, v232, s7, v230
  v_bfe_u32 v230, v32, 14, 5
  v_and_b32 v32, 0x3fff, v32
  v_mad_u32_u24 v32, v230, s5, v32
  s_cmp_eq_u64 s[22:23], 0
  s_cbranch_scc1 K2_unpS
  v_mul_hi_u32 v233, v233, s6
  v_lshrrev_b32 v230, 19, v33
  v_mad_u32_u24 v233, v233, s7, v230
  v_bfe_u32 v230, v33, 14, 5
  v_and_b32 v33, 0x3fff, v33
  v_mad_u32_u24 v33, v230, s5, v33
  s_cmp_eq_u64 s[24:25], 0
  s_cbranch_scc1 K2_unpS
  v_mul_hi_u32 v234, v234, s6
  v_lshrrev_b32 v230, 19, v34
  v_mad_u32_u24 v234, v234, s7, v230
  v_bfe_u32 v230, v34, 14, 5
  v_and_b32 v34, 0x3fff, v34
  v_mad_u32_u24 v34, v230, s5, v34
  s_cmp_eq_u64 s[26:27], 0
  s_cbranch_scc1 K2_unpS
  v_mul_hi_u32 v235, v235, s6
  v_lshrrev_b32 v230, 19, v35
  v_mad_u32_u24 v235, v235, s7, v230
  v_bfe_u32 v230, v35, 14, 5
  v_and_b32 v35, 0x3fff, v35
  v_mad_u32_u24 v35, v230, s5, v35
  s_cmp_eq_u64 s[28:29], 0
  s_cbranch_scc1 K2_unpS
  v_mul_hi_u32 v236, v236, s6
  v_lshrrev_b32 v230, 19, v36
  v_mad_u32_u24 v236, v236, s7, v230
  v_bfe_u32 v230, v36, 14, 5
  v_and_b32 v36, 0x3fff, v36
  v_mad_u32_u24 v36, v230, s5, v36
  s_cmp_eq_u64 s[30:31], 0
  s_cbranch_scc1 K2_unpS
  v_mul_hi_u32 v237, v237, s6
  v_lshrrev_b32 v230, 19, v37
  v_mad_u32_u24 v237, v237, s7, v230
  v_bfe_u32 v230, v37, 14, 5
  v_and_b32 v37, 0x3fff, v37
  v_mad_u32_u24 v37, v230, s5, v37
  s_cmp_eq_u64 s[64:65], 0
  s_cbranch_scc1 K2_unpS
  v_mul_hi_u32 v238, v238, s6
  v_lshrrev_b32 v230, 19, v38
  v_mad_u32_u24 v238, v238, s7, v230
  v_bfe_u32 v230, v38, 14, 5
  v_and_b32 v38, 0x3fff, v38
  v_mad_u32_u24 v38, v230, s5, v38
  s_cmp_eq_u64 s[68:69], 0
  s_cbranch_scc1 K2_unpS
  v_mul_hi_u32 v239, v239, s6
  v_lshrrev_b32 v230, 19, v39
  v_mad_u32_u24 v239, v239, s7, v230
  v_bfe_u32 v230, v39, 14, 5
  v_and_b32 v39, 0x3fff, v39
  v_mad_u32_u24 v39, v230, s5, v39
K2_unpS:
  v_lshl_add_u32 v231, v219, 2, s67
  s_cmp_eq_u64 s[20:21], 0
  s_cbranch_scc1 K2_plainS
  s_mov_b64 exec, s[20:21]
  ds_write_b32 v231, v32 offset:0
  ds_write_b32 v231, v232 offset:2432
  s_cmp_eq_u64 s[22:23], 0
  s_cbranch_scc1 K2_plainS
  s_mov_b64 exec, s[22:23]
  ds_write_b32 v231, v33 offset:256
  ds_write_b32 v231, v233 offset:2688
  s_cmp_eq_u64 s[24:25], 0
  s_cbranch_scc1 K2_plainS
  s_mov_b64 exec, s[24:25]
  ds_write_b32 v231, v34 offset:512
  ds_write_b32 v231, v234 offset:2944
  s_cmp_eq_u64 s[26:27], 0
  s_cbranch_scc1 K2_plainS
  s_mov_b64 exec, s[26:27]
  ds_write_b32 v231, v35 offset:768
  ds_write_b32 v231, v235 offset:3200
  s_cmp_eq_u64 s[28:29], 0
  s_cbranch_scc1 K2_plainS
  s_mov_b64 exec, s[28:29]
  ds_write_b32 v231, v36 offset:1024
  ds_write_b32 v231, v236 offset:3456
  s_cmp_eq_u64 s[30:31], 0
  s_cbranch_scc1 K2_plainS
  s_mov_b64 exec, s[30:31]
  ds_write_b32 v231, v37 offset:1280
  ds_write_b32 v231, v237 offset:3712
  s_cmp_eq_u64 s[64:65], 0
  s_cbranch_scc1 K2_plainS
  s_mov_b64 exec, s[64:65]
  ds_write_b32 v231, v38 offset:1536
  ds_write_b32 v231, v238 offset:3968
  s_cmp_eq_u64 s[68:69], 0
  s_cbranch_scc1 K2_plainS
  s_mov_b64 exec, s[68:69]
  ds_write_b32 v231, v39 offset:1792
  ds_write_b32 v231, v239 offset:4224
K2_plainS:
  s_mov_b64 exec, -1
K2_binned:
  s_waitcnt vmcnt(0) lgkmcnt(0)
  s_barrier
  ds_read_u16 v192, v208 offset:0
  ds_read_u16 v194, v208 offset:4
  ds_read_u16 v196, v208 offset:8
  ds_read_u16 v198, v208 offset:12
  ds_read_b32 v200, v209 offset:0
  ds_read_b32 v203, v210 offset:0
  s_waitcnt lgkmcnt(1)
  s_add_u32 m0, s58, 0
  s_nop 0
  buffer_load_dwordx4 v[192:193], s[16:19], s36 idxen offen offset:0 lds
  buffer_load_dwordx4 v[194:195], s[16:19], s37 idxen offen offset:1024 lds
  buffer_load_dwordx4 v[196:197], s[16:19], s38 idxen offen offset:2048 lds
  buffer_load_dwordx4 v[198:199], s[16:19], 0 idxen offen offset:3072 lds
  s_add_u32 m0, s58, 4096
  s_nop 0
  buffer_load_dwordx4 v[200:201], s[12:15], 0 idxen offen lds
  ds_read_u16 v192, v208 offset:128
  ds_read_u16 v194, v208 offset:132
  ds_read_u16 v196, v208 offset:136
  ds_read_u16 v198, v208 offset:140
  ds_read_b32 v200, v209 offset:128
  s_waitcnt lgkmcnt(0)
  s_add_u32 m0, s58, 5120
  s_nop 0
  buffer_load_dwordx4 v[192:193], s[16:19], s36 idxen offen offset:0 lds
  buffer_load_dwordx4 v[194:195], s[16:19], s37 idxen offen offset:1024 lds
  buffer_load_dwordx4 v[196:197], s[16:19], s38 idxen offen offset:2048 lds
  buffer_load_dwordx4 v[198:199], s[16:19], 0 idxen offen offset:3072 lds
  s_add_u32 m0, s58, 9216
  s_nop 0
  buffer_load_dwordx4 v[200:201], s[12:15], 0 idxen offen lds
  s_lshl_b32 s4, s51, 6
  v_add_u32 v227, s4, v222
  v_xor_b32 v227, v227, v225
  v_add_u32 v221, v221, v227
  s_mul_i32 s4, s50, 20
  v_add_u32 v227, s4, v224
  v_xor_b32 v228, v227, v223
  v_and_b32 v228, 15, v228
  v_lshlrev_b32 v228, 4, v228
  v_lshl_add_u32 v226, v227, 8, v228
  v_add_u32 v226, 116736, v226
  ds_read_b128 v[48:51], v226
  v_xor_b32 v227, 32, v226
  ds_read_b128 v[52:55], v227
  v_xor_b32 v227, 64, v226
  ds_read_b128 v[56:59], v227
  v_xor_b32 v227, 96, v226
  ds_read_b128 v[60:63], v227
  v_xor_b32 v227, 128, v226
  ds_read_b128 v[80:83], v227
  v_xor_b32 v227, 160, v226
  ds_read_b128 v[84:87], v227
  v_xor_b32 v227, 192, v226
  ds_read_b128 v[88:91], v227
  v_xor_b32 v227, 224, v226
  ds_read_b128 v[92:95], v227
  ds_read_b64_tr_b16 v[156:157], v221 offset:32768
  ds_read_b64_tr_b16 v[158:159], v221 offset:33280
  s_lshl_b32 s52, s49, 2
  s_add_u32 s52, s52, s50
  s_mul_i32 s53, s52, 20
  v_lshlrev_b32 v234, 10, v223
  v_lshl_add_u32 v238, v224, 1, v234
  s_lshl_b32 s4, s53, 8
  s_lshl_b32 s5, s48, 7
  s_add_u32 s4, s4, s5
  s_lshl_b32 s5, s51, 6
  s_add_u32 s63, s4, s5
  s_add_u32 s5, s63, 4096
  buffer_load_ushort v180, v238, s[8:11], s63 offen offset:0
  buffer_load_ushort v181, v238, s[8:11], s63 offen offset:256
  buffer_load_ushort v182, v238, s[8:11], s63 offen offset:512
  buffer_load_ushort v183, v238, s[8:11], s63 offen offset:768
  buffer_load_ushort v184, v238, s[8:11], s63 offen offset:2048
  buffer_load_ushort v185, v238, s[8:11], s63 offen offset:2304
  buffer_load_ushort v186, v238, s[8:11], s63 offen offset:2560
  buffer_load_ushort v187, v238, s[8:11], s63 offen offset:2816
  buffer_load_ushort v188, v238, s[8:11], s5 offen offset:0
  buffer_load_ushort v189, v238, s[8:11], s5 offen offset:256
  buffer_load_ushort v190, v238, s[8:11], s5 offen offset:512
  buffer_load_ushort v191, v238, s[8:11], s5 offen offset:768
  s_waitcnt lgkmcnt(0)
  ds_read_b64_tr_b16 v[112:113], v221 offset:0
  ds_read_b64_tr_b16 v[114:115], v221 offset:512
  ds_read_b64_tr_b16 v[116:117], v221 offset:2048
  ds_read_b64_tr_b16 v[118:119], v221 offset:2560
  ds_read_b64_tr_b16 v[120:121], v221 offset:4096
  ds_read_b64_tr_b16 v[122:123], v221 offset:4608
  s_waitcnt lgkmcnt(4)
  v_mfma_f32_32x32x16_bf16 v[32:47], v[48:51], v[112:115], 0
  ds_read_b64_tr_b16 v[124:125], v221 offset:6144
  ds_read_b64_tr_b16 v[126:127], v221 offset:6656
  s_waitcnt lgkmcnt(4)
  v_mfma_f32_32x32x16_bf16 v[32:47], v[52:55], v[116:119], v[32:47]
  ds_read_b64_tr_b16 v[128:129], v221 offset:8192
  ds_read_b64_tr_b16 v[130:131], v221 offset:8704
  s_waitcnt lgkmcnt(4)
  v_mfma_f32_32x32x16_bf16 v[32:47], v[56:59], v[120:123], v[32:47]
  ds_read_b64_tr_b16 v[132:133], v221 offset:10240
  ds_read_b64_tr_b16 v[134:135], v221 offset:10752
  s_waitcnt lgkmcnt(4)
  v_mfma_f32_32x32x16_bf16 v[32:47], v[60:63], v[124:127], v[32:47]
  ds_read_b64_tr_b16 v[136:137], v221 offset:12288
  ds_read_b64_tr_b16 v[138:139], v221 offset:12800
  s_waitcnt lgkmcnt(4)
  v_mfma_f32_32x32x16_bf16 v[32:47], v[80:83], v[128:131], v[32:47]
  ds_read_b64_tr_b16 v[140:141], v221 offset:14336
  ds_read_b64_tr_b16 v[142:143], v221 offset:14848
  s_waitcnt lgkmcnt(4)
  v_mfma_f32_32x32x16_bf16 v[32:47], v[84:87], v[132:135], v[32:47]
  s_waitcnt lgkmcnt(2)
  v_mfma_f32_32x32x16_bf16 v[32:47], v[88:91], v[136:139], v[32:47]
  s_waitcnt lgkmcnt(0)
  v_mfma_f32_32x32x16_bf16 v[32:47], v[92:95], v[140:143], v[32:47]
  s_mov_b32 s4, 0xbfb8aa3b
  v_lshlrev_b32 v227, 16, v156
  v_and_b32 v228, 0xffff0000, v156
  v_mul_f32 v227, s4, v227
  v_mul_f32 v228, s4, v228
  v_cvt_pk_bf16_f32 v156, v227, v228
  v_lshlrev_b32 v227, 16, v157
  v_and_b32 v228, 0xffff0000, v157
  v_mul_f32 v227, s4, v227
  v_mul_f32 v228, s4, v228
  v_cvt_pk_bf16_f32 v157, v227, v228
  v_lshlrev_b32 v227, 16, v158
  v_and_b32 v228, 0xffff0000, v158
  v_mul_f32 v227, s4, v227
  v_mul_f32 v228, s4, v228
  v_cvt_pk_bf16_f32 v158, v227, v228
  v_lshlrev_b32 v227, 16, v159
  v_and_b32 v228, 0xffff0000, v159
  v_mul_f32 v227, s4, v227
  v_mul_f32 v228, s4, v228
  v_cvt_pk_bf16_f32 v159, v227, v228
  v_mul_f32 v32, s4, v32
  v_mul_f32 v33, s4, v33
  v_mul_f32 v34, s4, v34
  v_mul_f32 v35, s4, v35
  v_mul_f32 v36, s4, v36
  v_mul_f32 v37, s4, v37
  v_mul_f32 v38, s4, v38
  v_mul_f32 v39, s4, v39
  v_mul_f32 v40, s4, v40
  v_mul_f32 v41, s4, v41
  v_mul_f32 v42, s4, v42
  v_mul_f32 v43, s4, v43
  v_mul_f32 v44, s4, v44
  v_mul_f32 v45, s4, v45
  v_mul_f32 v46, s4, v46
  v_mul_f32 v47, s4, v47
  v_cvt_pk_bf16_f32 v160, v32, v33
  v_cvt_pk_bf16_f32 v161, v34, v35
  v_cvt_pk_bf16_f32 v162, v36, v37
  v_cvt_pk_bf16_f32 v163, v38, v39
  v_cvt_pk_bf16_f32 v164, v40, v41
  v_cvt_pk_bf16_f32 v165, v42, v43
  v_cvt_pk_bf16_f32 v166, v44, v45
  v_cvt_pk_bf16_f32 v167, v46, v47
  ds_read_b64_tr_b16 v[112:113], v221 offset:16384
  ds_read_b64_tr_b16 v[114:115], v221 offset:16896
  ds_read_b64_tr_b16 v[116:117], v221 offset:18432
  ds_read_b64_tr_b16 v[118:119], v221 offset:18944
  ds_read_b64_tr_b16 v[120:121], v221 offset:20480
  ds_read_b64_tr_b16 v[122:123], v221 offset:20992
  s_waitcnt lgkmcnt(4)
  v_mfma_f32_32x32x16_bf16 v[64:79], v[48:51], v[112:115], 0
  ds_read_b64_tr_b16 v[124:125], v221 offset:22528
  ds_read_b64_tr_b16 v[126:127], v221 offset:23040
  s_waitcnt lgkmcnt(4)
  v_mfma_f32_32x32x16_bf16 v[64:79], v[52:55], v[116:119], v[64:79]
  ds_read_b64_tr_b16 v[128:129], v221 offset:24576
  ds_read_b64_tr_b16 v[130:131], v221 offset:25088
  s_waitcnt lgkmcnt(4)
  v_mfma_f32_32x32x16_bf16 v[64:79], v[56:59], v[120:123], v[64:79]
  ds_read_b64_tr_b16 v[132:133], v221 offset:26624
  ds_read_b64_tr_b16 v[134:135], v221 offset:27136
  s_waitcnt lgkmcnt(4)
  v_mfma_f32_32x32x16_bf16 v[64:79], v[60:63], v[124:127], v[64:79]
  ds_read_b64_tr_b16 v[136:137], v221 offset:28672
  ds_read_b64_tr_b16 v[138:139], v221 offset:29184
  s_waitcnt lgkmcnt(4)
  v_mfma_f32_32x32x16_bf16 v[64:79], v[80:83], v[128:131], v[64:79]
  ds_read_b64_tr_b16 v[140:141], v221 offset:30720
  ds_read_b64_tr_b16 v[142:143], v221 offset:31232
  s_waitcnt lgkmcnt(4)
  v_mfma_f32_32x32x16_bf16 v[64:79], v[84:87], v[132:135], v[64:79]
  s_waitcnt lgkmcnt(2)
  v_mfma_f32_32x32x16_bf16 v[64:79], v[88:91], v[136:139], v[64:79]
  s_waitcnt lgkmcnt(0)
  v_mfma_f32_32x32x16_bf16 v[64:79], v[92:95], v[140:143], v[64:79]
  s_nop 7
  s_nop 7
  v_mov_b32 v168, v64
  v_mov_b32 v169, v65
  v_mov_b32 v170, v66
  v_mov_b32 v171, v67
  v_mov_b32 v172, v68
  v_mov_b32 v173, v69
  v_mov_b32 v174, v70
  v_mov_b32 v175, v71
  v_mov_b32 v176, v72
  v_mov_b32 v177, v73
  v_mov_b32 v178, v74
  v_mov_b32 v179, v75
  s_branch K2_joined
K2_late:
  s_lshl_b32 s4, s51, 6
  v_add_u32 v227, s4, v222
  v_xor_b32 v227, v227, v225
  v_add_u32 v221, v221, v227
  s_mul_i32 s4, s50, 20
  v_add_u32 v227, s4, v224
  v_xor_b32 v228, v227, v223
  v_and_b32 v228, 15, v228
  v_lshlrev_b32 v228, 4, v228
  v_lshl_add_u32 v226, v227, 8, v228
  v_add_u32 v226, 116736, v226
  ds_read_b128 v[48:51], v226
  v_xor_b32 v227, 32, v226
  ds_read_b128 v[52:55], v227
  v_xor_b32 v227, 64, v226
  ds_read_b128 v[56:59], v227
  v_xor_b32 v227, 96, v226
  ds_read_b128 v[60:63], v227
  v_xor_b32 v227, 128, v226
  ds_read_b128 v[80:83], v227
  v_xor_b32 v227, 160, v226
  ds_read_b128 v[84:87], v227
  v_xor_b32 v227, 192, v226
  ds_read_b128 v[88:91], v227
  v_xor_b32 v227, 224, v226
  ds_read_b128 v[92:95], v227
  ds_read_b64_tr_b16 v[156:157], v221 offset:32768
  ds_read_b64_tr_b16 v[158:159], v221 offset:33280
  s_lshl_b32 s52, s49, 2
  s_add_u32 s52, s52, s50
  s_mul_i32 s53, s52, 20
  v_lshlrev_b32 v234, 10, v223
  v_lshl_add_u32 v238, v224, 1, v234
  s_lshl_b32 s4, s53, 8
  s_lshl_b32 s5, s48, 7
  s_add_u32 s4, s4, s5
  s_lshl_b32 s5, s51, 6
  s_add_u32 s63, s4, s5
  s_add_u32 s5, s63, 4096
  buffer_load_ushort v180, v238, s[8:11], s63 offen offset:0
  buffer_load_ushort v181, v238, s[8:11], s63 offen offset:256
  buffer_load_ushort v182, v238, s[8:11], s63 offen offset:512
  buffer_load_ushort v183, v238, s[8:11], s63 offen offset:768
  buffer_load_ushort v184, v238, s[8:11], s63 offen offset:2048
  buffer_load_ushort v185, v238, s[8:11], s63 offen offset:2304
  buffer_load_ushort v186, v238, s[8:11], s63 offen offset:2560
  buffer_load_ushort v187, v238, s[8:11], s63 offen offset:2816
  buffer_load_ushort v188, v238, s[8:11], s5 offen offset:0
  buffer_load_ushort v189, v238, s[8:11], s5 offen offset:256
  buffer_load_ushort v190, v238, s[8:11], s5 offen offset:512
  buffer_load_ushort v191, v238, s[8:11], s5 offen offset:768
  s_waitcnt lgkmcnt(0)
  ds_read_b64_tr_b16 v[112:113], v221 offset:0
  ds_read_b64_tr_b16 v[114:115], v221 offset:512
  ds_read_b64_tr_b16 v[116:117], v221 offset:2048
  ds_read_b64_tr_b16 v[118:119], v221 offset:2560
  ds_read_b64_tr_b16 v[120:121], v221 offset:4096
  ds_read_b64_tr_b16 v[122:123], v221 offset:4608
  s_waitcnt lgkmcnt(4)
  v_mfma_f32_32x32x16_bf16 v[32:47], v[48:51], v[112:115], 0
  ds_read_b64_tr_b16 v[124:125], v221 offset:6144
  ds_read_b64_tr_b16 v[126:127], v221 offset:6656
  s_waitcnt lgkmcnt(4)
  v_mfma_f32_32x32x16_bf16 v[32:47], v[52:55], v[116:119], v[32:47]
  ds_read_b64_tr_b16 v[128:129], v221 offset:8192
  ds_read_b64_tr_b16 v[130:131], v221 offset:8704
  s_waitcnt lgkmcnt(4)
  v_mfma_f32_32x32x16_bf16 v[32:47], v[56:59], v[120:123], v[32:47]
  ds_read_b64_tr_b16 v[132:133], v221 offset:10240
  ds_read_b64_tr_b16 v[134:135], v221 offset:10752
  s_waitcnt lgkmcnt(4)
  v_mfma_f32_32x32x16_bf16 v[32:47], v[60:63], v[124:127], v[32:47]
  ds_read_b64_tr_b16 v[136:137], v221 offset:12288
  ds_read_b64_tr_b16 v[138:139], v221 offset:12800
  s_waitcnt lgkmcnt(4)
  v_mfma_f32_32x32x16_bf16 v[32:47], v[80:83], v[128:131], v[32:47]
  ds_read_b64_tr_b16 v[140:141], v221 offset:14336
  ds_read_b64_tr_b16 v[142:143], v221 offset:14848
  s_waitcnt lgkmcnt(4)
  v_mfma_f32_32x32x16_bf16 v[32:47], v[84:87], v[132:135], v[32:47]
  s_waitcnt lgkmcnt(2)
  v_mfma_f32_32x32x16_bf16 v[32:47], v[88:91], v[136:139], v[32:47]
  s_waitcnt lgkmcnt(0)
  v_mfma_f32_32x32x16_bf16 v[32:47], v[92:95], v[140:143], v[32:47]
  s_mov_b32 s4, 0xbfb8aa3b
  v_lshlrev_b32 v227, 16, v156
  v_and_b32 v228, 0xffff0000, v156
  v_mul_f32 v227, s4, v227
  v_mul_f32 v228, s4, v228
  v_cvt_pk_bf16_f32 v156, v227, v228
  v_lshlrev_b32 v227, 16, v157
  v_and_b32 v228, 0xffff0000, v157
  v_mul_f32 v227, s4, v227
  v_mul_f32 v228, s4, v228
  v_cvt_pk_bf16_f32 v157, v227, v228
  v_lshlrev_b32 v227, 16, v158
  v_and_b32 v228, 0xffff0000, v158
  v_mul_f32 v227, s4, v227
  v_mul_f32 v228, s4, v228
  v_cvt_pk_bf16_f32 v158, v227, v228
  v_lshlrev_b32 v227, 16, v159
  v_and_b32 v228, 0xffff0000, v159
  v_mul_f32 v227, s4, v227
  v_mul_f32 v228, s4, v228
  v_cvt_pk_bf16_f32 v159, v227, v228
  v_mul_f32 v32, s4, v32
  v_mul_f32 v33, s4, v33
  v_mul_f32 v34, s4, v34
  v_mul_f32 v35, s4, v35
  v_mul_f32 v36, s4, v36
  v_mul_f32 v37, s4, v37
  v_mul_f32 v38, s4, v38
  v_mul_f32 v39, s4, v39
  v_mul_f32 v40, s4, v40
  v_mul_f32 v41, s4, v41
  v_mul_f32 v42, s4, v42
  v_mul_f32 v43, s4, v43
  v_mul_f32 v44, s4, v44
  v_mul_f32 v45, s4, v45
  v_mul_f32 v46, s4, v46
  v_mul_f32 v47, s4, v47
  v_cvt_pk_bf16_f32 v160, v32, v33
  v_cvt_pk_bf16_f32 v161, v34, v35
  v_cvt_pk_bf16_f32 v162, v36, v37
  v_cvt_pk_bf16_f32 v163, v38, v39
  v_cvt_pk_bf16_f32 v164, v40, v41
  v_cvt_pk_bf16_f32 v165, v42, v43
  v_cvt_pk_bf16_f32 v166, v44, v45
  v_cvt_pk_bf16_f32 v167, v46, v47
  s_waitcnt lgkmcnt(0)
  s_barrier
  ds_read_b64_tr_b16 v[112:113], v221 offset:16384
  ds_read_b64_tr_b16 v[114:115], v221 offset:16896
  ds_read_b64_tr_b16 v[116:117], v221 offset:18432
  ds_read_b64_tr_b16 v[118:119], v221 offset:18944
  ds_read_b64_tr_b16 v[120:121], v221 offset:20480
  ds_read_b64_tr_b16 v[122:123], v221 offset:20992
  s_waitcnt lgkmcnt(4)
  v_mfma_f32_32x32x16_bf16 v[64:79], v[48:51], v[112:115], 0
  ds_read_b64_tr_b16 v[124:125], v221 offset:22528
  ds_read_b64_tr_b16 v[126:127], v221 offset:23040
  s_waitcnt lgkmcnt(4)
  v_mfma_f32_32x32x16_bf16 v[64:79], v[52:55], v[116:119], v[64:79]
  ds_read_b64_tr_b16 v[128:129], v221 offset:24576
  ds_read_b64_tr_b16 v[130:131], v221 offset:25088
  s_waitcnt lgkmcnt(4)
  v_mfma_f32_32x32x16_bf16 v[64:79], v[56:59], v[120:123], v[64:79]
  ds_read_b64_tr_b16 v[132:133], v221 offset:26624
  ds_read_b64_tr_b16 v[134:135], v221 offset:27136
  s_waitcnt lgkmcnt(4)
  v_mfma_f32_32x32x16_bf16 v[64:79], v[60:63], v[124:127], v[64:79]
  ds_read_b64_tr_b16 v[136:137], v221 offset:28672
  ds_read_b64_tr_b16 v[138:139], v221 offset:29184
  s_waitcnt lgkmcnt(4)
  v_mfma_f32_32x32x16_bf16 v[64:79], v[80:83], v[128:131], v[64:79]
  ds_read_b64_tr_b16 v[140:141], v221 offset:30720
  ds_read_b64_tr_b16 v[142:143], v221 offset:31232
  s_waitcnt lgkmcnt(4)
  v_mfma_f32_32x32x16_bf16 v[64:79], v[84:87], v[132:135], v[64:79]
  s_waitcnt lgkmcnt(2)
  v_mfma_f32_32x32x16_bf16 v[64:79], v[88:91], v[136:139], v[64:79]
  s_waitcnt lgkmcnt(0)
  v_mfma_f32_32x32x16_bf16 v[64:79], v[92:95], v[140:143], v[64:79]
  s_nop 7
  s_nop 7
  v_mov_b32 v168, v64
  v_mov_b32 v169, v65
  v_mov_b32 v170, v66
  v_mov_b32 v171, v67
  v_mov_b32 v172, v68
  v_mov_b32 v173, v69
  v_mov_b32 v174, v70
  v_mov_b32 v175, v71
  v_mov_b32 v176, v72
  v_mov_b32 v177, v73
  v_mov_b32 v178, v74
  v_mov_b32 v179, v75
  ds_read_u16 v192, v208 offset:0
  ds_read_u16 v194, v208 offset:4
  ds_read_u16 v196, v208 offset:8
  ds_read_u16 v198, v208 offset:12
  ds_read_b32 v200, v209 offset:0
  ds_read_b32 v203, v210 offset:0
  s_waitcnt lgkmcnt(1)
  s_add_u32 m0, s58, 0
  s_nop 0
  buffer_load_dwordx4 v[192:193], s[16:19], s36 idxen offen offset:0 lds
  buffer_load_dwordx4 v[194:195], s[16:19], s37 idxen offen offset:1024 lds
  buffer_load_dwordx4 v[196:197], s[16:19], s38 idxen offen offset:2048 lds
  buffer_load_dwordx4 v[198:199], s[16:19], 0 idxen offen offset:3072 lds
  s_add_u32 m0, s58, 4096
  s_nop 0
  buffer_load_dwordx4 v[200:201], s[12:15], 0 idxen offen lds
  ds_read_u16 v192, v208 offset:128
  ds_read_u16 v194, v208 offset:132
  ds_read_u16 v196, v208 offset:136
  ds_read_u16 v198, v208 offset:140
  ds_read_b32 v200, v209 offset:128
  s_waitcnt lgkmcnt(0)
  s_add_u32 m0, s58, 5120
  s_nop 0
  buffer_load_dwordx4 v[192:193], s[16:19], s36 idxen offen offset:0 lds
  buffer_load_dwordx4 v[194:195], s[16:19], s37 idxen offen offset:1024 lds
  buffer_load_dwordx4 v[196:197], s[16:19], s38 idxen offen offset:2048 lds
  buffer_load_dwordx4 v[198:199], s[16:19], 0 idxen offen offset:3072 lds
  s_add_u32 m0, s58, 9216
  s_nop 0
  buffer_load_dwordx4 v[200:201], s[12:15], 0 idxen offen lds
K2_joined:
  v_add_u32_sdwa v202, v203, v217 dst_sel:DWORD dst_unused:UNUSED_PAD src0_sel:WORD_1 src1_sel:DWORD
K2_window:
  s_add_u32 s57, s59, 31
  s_lshr_b32 s57, s57, 5
  s_cmp_eq_u32 s57, 0
  s_cbranch_scc1 K2_roundend
  s_waitcnt vmcnt(5) lgkmcnt(0)
  ds_read_b128 v[112:115], v202 offset:0
  ds_read_b128 v[116:119], v202 offset:32
  ds_read_b128 v[120:123], v216 offset:0
  ds_read_b128 v[124:127], v212 offset:0
  ds_read_b128 v[132:135], v214 offset:0
  ds_read_b128 v[128:131], v213 offset:0
  ds_read_b128 v[136:139], v215 offset:0
  ds_read_u16 v192, v208 offset:256
  ds_read_u16 v194, v208 offset:260
  ds_read_u16 v196, v208 offset:264
  ds_read_u16 v198, v208 offset:268
  ds_read_b32 v200, v209 offset:256
  ds_read_b32 v203, v210 offset:128
  s_waitcnt lgkmcnt(6)
  v_mfma_f32_32x32x16_bf16 v[32:47], v[112:115], v[160:163], 0
  v_mfma_f32_32x32x16_bf16 v[64:79], v[132:135], v[148:151], 0
  v_mfma_f32_32x32x16_bf16 v[32:47], v[116:119], v[164:167], v[32:47]
  v_mfma_f32_32x32x16_bf16 v[64:79], v[136:139], v[152:155], v[64:79]
  v_mfma_f32_32x32x16_bf16 v[32:47], v[120:123], v[156:159], v[32:47]
  v_mfma_f32_32x32x16_bf16 v[32:47], v[124:127], v[148:151], v[32:47]
  v_mfma_f32_32x32x16_bf16 v[32:47], v[128:131], v[152:155], v[32:47]
  s_waitcnt lgkmcnt(1)
  s_add_u32 m0, s58, 0
  s_nop 0
  buffer_load_dwordx4 v[192:193], s[16:19], s36 idxen offen offset:0 lds
  buffer_load_dwordx4 v[194:195], s[16:19], s37 idxen offen offset:1024 lds
  buffer_load_dwordx4 v[196:197], s[16:19], s38 idxen offen offset:2048 lds
  buffer_load_dwordx4 v[198:199], s[16:19], 0 idxen offen offset:3072 lds
  s_add_u32 m0, s58, 4096
  s_nop 0
  buffer_load_dwordx4 v[200:201], s[12:15], 0 idxen offen lds
  s_waitcnt lgkmcnt(0)
  v_add_u32_sdwa v202, v203, v217 dst_sel:DWORD dst_unused:UNUSED_PAD src0_sel:WORD_1 src1_sel:DWORD
  v_add_u32 v204, 1600, v218
  v_add_u32 v205, 1600, v218
  v_add_u32 v206, 1600, v218
  v_add_u32 v207, 1600, v218
  s_mov_b32 s6, 1.0
  s_mov_b32 s7, 1.0
  s_waitcnt vmcnt(5)
  ds_read_b64_tr_b16 v[140:141], v204
  ds_read_b64_tr_b16 v[142:143], v205
  ds_read_b64_tr_b16 v[144:145], v206
  ds_read_b64_tr_b16 v[146:147], v207
  ds_read_b128 v[112:115], v202 offset:0
  ds_read_b128 v[116:119], v202 offset:32
  ds_read_b128 v[120:123], v216 offset:5120
  ds_read_b128 v[124:127], v212 offset:5120
  ds_read_b128 v[132:135], v214 offset:5120
  ds_read_b128 v[128:131], v213 offset:5120
  ds_read_b128 v[136:139], v215 offset:5120
  s_waitcnt lgkmcnt(4)
  ds_read_u16 v192, v208 offset:384
  ds_read_u16 v194, v208 offset:388
  ds_read_u16 v196, v208 offset:392
  ds_read_u16 v198, v208 offset:396
  ds_read_b32 v200, v209 offset:384
  ds_read_b32 v203, v210 offset:256
  ds_read_b128 v[204:207], v211 offset:0
  s_waitcnt lgkmcnt(0)
  s_setprio 1
  v_mfma_f32_32x32x16_bf16 v[0:15], v[140:143], v[104:107], v[0:15]
  v_exp_f32 v32, v32
  v_exp_f32 v33, v33
  v_exp_f32 v34, v34
  v_mfma_f32_32x32x16_bf16 v[16:31], v[140:143], v[96:99], v[16:31]
  v_exp_f32 v35, v35
  v_exp_f32 v36, v36
  v_exp_f32 v37, v37
  v_exp_f32 v38, v38
  v_exp_f32 v39, v39
  s_setprio 2
  v_pk_add_f32 v[32:33], v[32:33], s[6:7]
  v_pk_add_f32 v[34:35], v[34:35], s[6:7]
  v_pk_add_f32 v[36:37], v[36:37], s[6:7]
  v_pk_add_f32 v[38:39], v[38:39], s[6:7]
  v_mfma_f32_32x32x16_bf16 v[48:63], v[112:115], v[160:163], 0
  v_rcp_f32 v32, v32
  v_rcp_f32 v33, v33
  v_rcp_f32 v34, v34
  v_mfma_f32_32x32x16_bf16 v[80:95], v[132:135], v[148:151], 0
  v_rcp_f32 v35, v35
  v_rcp_f32 v36, v36
  v_rcp_f32 v37, v37
  v_rcp_f32 v38, v38
  v_rcp_f32 v39, v39
  s_setprio 3
  v_pk_mul_f32 v[64:65], v[32:33], v[64:65]
  v_pk_mul_f32 v[66:67], v[34:35], v[66:67]
  v_pk_mul_f32 v[68:69], v[36:37], v[68:69]
  v_pk_mul_f32 v[70:71], v[38:39], v[70:71]
  v_mfma_f32_32x32x16_bf16 v[48:63], v[116:119], v[164:167], v[48:63]
  v_add_u32_sdwa v202, v203, v217 dst_sel:DWORD dst_unused:UNUSED_PAD src0_sel:WORD_1 src1_sel:DWORD
  v_add_u32_sdwa v204, v204, v218 dst_sel:DWORD dst_unused:UNUSED_PAD src0_sel:WORD_1 src1_sel:DWORD
  v_add_u32_sdwa v205, v205, v218 dst_sel:DWORD dst_unused:UNUSED_PAD src0_sel:WORD_1 src1_sel:DWORD
  v_add_u32_sdwa v206, v206, v218 dst_sel:DWORD dst_unused:UNUSED_PAD src0_sel:WORD_1 src1_sel:DWORD
  v_add_u32_sdwa v207, v207, v218 dst_sel:DWORD dst_unused:UNUSED_PAD src0_sel:WORD_1 src1_sel:DWORD
  v_cvt_pk_bf16_f32 v96, v32, v33
  v_cvt_pk_bf16_f32 v97, v34, v35
  v_cvt_pk_bf16_f32 v98, v36, v37
  v_cvt_pk_bf16_f32 v99, v38, v39
  v_cvt_pk_bf16_f32 v104, v64, v65
  v_cvt_pk_bf16_f32 v105, v66, v67
  v_cvt_pk_bf16_f32 v106, v68, v69
  v_cvt_pk_bf16_f32 v107, v70, v71
  v_mfma_f32_32x32x16_bf16 v[0:15], v[144:147], v[108:111], v[0:15]
  v_exp_f32 v40, v40
  v_exp_f32 v41, v41
  v_exp_f32 v42, v42
  v_mfma_f32_32x32x16_bf16 v[48:63], v[120:123], v[156:159], v[48:63]
  v_exp_f32 v43, v43
  v_exp_f32 v44, v44
  v_exp_f32 v45, v45
  v_exp_f32 v46, v46
  v_exp_f32 v47, v47
  v_pk_add_f32 v[40:41], v[40:41], s[6:7]
  v_pk_add_f32 v[42:43], v[42:43], s[6:7]
  v_pk_add_f32 v[44:45], v[44:45], s[6:7]
  v_pk_add_f32 v[46:47], v[46:47], s[6:7]
  v_mfma_f32_32x32x16_bf16 v[16:31], v[144:147], v[100:103], v[16:31]
  v_rcp_f32 v40, v40
  v_rcp_f32 v41, v41
  v_rcp_f32 v42, v42
  v_mfma_f32_32x32x16_bf16 v[48:63], v[124:127], v[148:151], v[48:63]
  v_rcp_f32 v43, v43
  v_rcp_f32 v44, v44
  v_rcp_f32 v45, v45
  v_rcp_f32 v46, v46
  v_rcp_f32 v47, v47
  v_pk_mul_f32 v[72:73], v[40:41], v[72:73]
  v_pk_mul_f32 v[74:75], v[42:43], v[74:75]
  v_pk_mul_f32 v[76:77], v[44:45], v[76:77]
  v_pk_mul_f32 v[78:79], v[46:47], v[78:79]
  v_mfma_f32_32x32x16_bf16 v[80:95], v[136:139], v[152:155], v[80:95]
  v_cvt_pk_bf16_f32 v100, v40, v41
  v_cvt_pk_bf16_f32 v101, v42, v43
  v_cvt_pk_bf16_f32 v102, v44, v45
  v_mfma_f32_32x32x16_bf16 v[48:63], v[128:131], v[152:155], v[48:63]
  v_cvt_pk_bf16_f32 v103, v46, v47
  v_cvt_pk_bf16_f32 v108, v72, v73
  v_cvt_pk_bf16_f32 v109, v74, v75
  v_cvt_pk_bf16_f32 v110, v76, v77
  v_cvt_pk_bf16_f32 v111, v78, v79
  s_setprio 0
  s_add_u32 m0, s58, 5120
  s_nop 0
  buffer_load_dwordx4 v[192:193], s[16:19], s36 idxen offen offset:0 lds
  buffer_load_dwordx4 v[194:195], s[16:19], s37 idxen offen offset:1024 lds
  buffer_load_dwordx4 v[196:197], s[16:19], s38 idxen offen offset:2048 lds
  buffer_load_dwordx4 v[198:199], s[16:19], 0 idxen offen offset:3072 lds
  s_add_u32 m0, s58, 9216
  s_nop 0
  buffer_load_dwordx4 v[200:201], s[12:15], 0 idxen offen lds
  s_sub_u32 s57, s57, 1
  s_cmp_eq_u32 s57, 0
  s_cbranch_scc1 K2_drain
  s_branch K2_loop1
K2_loop:
  s_waitcnt vmcnt(5)
  ds_read_b64_tr_b16 v[140:141], v204
  ds_read_b64_tr_b16 v[142:143], v205
  ds_read_b64_tr_b16 v[144:145], v206
  ds_read_b64_tr_b16 v[146:147], v207
  ds_read_b128 v[112:115], v202 offset:0
  ds_read_b128 v[116:119], v202 offset:32
  ds_read_b128 v[120:123], v216 offset:5120
  ds_read_b128 v[124:127], v212 offset:5120
  ds_read_b128 v[132:135], v214 offset:5120
  ds_read_b128 v[128:131], v213 offset:5120
  ds_read_b128 v[136:139], v215 offset:5120
  s_waitcnt lgkmcnt(4)
  ds_read_u16 v192, v208 offset:384
  ds_read_u16 v194, v208 offset:388
  ds_read_u16 v196, v208 offset:392
  ds_read_u16 v198, v208 offset:396
  ds_read_b32 v200, v209 offset:384
  ds_read_b32 v203, v210 offset:256
  ds_read_b128 v[204:207], v211 offset:0
  s_waitcnt lgkmcnt(2)
  s_add_u32 m0, s58, 5120
  s_nop 0
  buffer_load_dwordx4 v[192:193], s[16:19], s36 idxen offen offset:0 lds
  buffer_load_dwordx4 v[194:195], s[16:19], s37 idxen offen offset:1024 lds
  buffer_load_dwordx4 v[196:197], s[16:19], s38 idxen offen offset:2048 lds
  buffer_load_dwordx4 v[198:199], s[16:19], 0 idxen offen offset:3072 lds
  s_add_u32 m0, s58, 9216
  s_nop 0
  buffer_load_dwordx4 v[200:201], s[12:15], 0 idxen offen lds
  s_waitcnt lgkmcnt(0)
  s_setprio 1
  v_mfma_f32_32x32x16_bf16 v[0:15], v[140:143], v[104:107], v[0:15]
  v_exp_f32 v32, v32
  v_exp_f32 v33, v33
  v_exp_f32 v34, v34
  v_mfma_f32_32x32x16_bf16 v[16:31], v[140:143], v[96:99], v[16:31]
  v_exp_f32 v35, v35
  v_exp_f32 v36, v36
  v_exp_f32 v37, v37
  v_exp_f32 v38, v38
  v_exp_f32 v39, v39
  s_setprio 2
  v_pk_add_f32 v[32:33], v[32:33], s[6:7]
  v_pk_add_f32 v[34:35], v[34:35], s[6:7]
  v_pk_add_f32 v[36:37], v[36:37], s[6:7]
  v_pk_add_f32 v[38:39], v[38:39], s[6:7]
  v_mfma_f32_32x32x16_bf16 v[48:63], v[112:115], v[160:163], 0
  v_rcp_f32 v32, v32
  v_rcp_f32 v33, v33
  v_rcp_f32 v34, v34
  v_mfma_f32_32x32x16_bf16 v[80:95], v[132:135], v[148:151], 0
  v_rcp_f32 v35, v35
  v_rcp_f32 v36, v36
  v_rcp_f32 v37, v37
  v_rcp_f32 v38, v38
  v_rcp_f32 v39, v39
  s_setprio 3
  v_pk_mul_f32 v[64:65], v[32:33], v[64:65]
  v_pk_mul_f32 v[66:67], v[34:35], v[66:67]
  v_pk_mul_f32 v[68:69], v[36:37], v[68:69]
  v_pk_mul_f32 v[70:71], v[38:39], v[70:71]
  v_mfma_f32_32x32x16_bf16 v[48:63], v[116:119], v[164:167], v[48:63]
  v_add_u32_sdwa v202, v203, v217 dst_sel:DWORD dst_unused:UNUSED_PAD src0_sel:WORD_1 src1_sel:DWORD
  v_add_u32_sdwa v204, v204, v218 dst_sel:DWORD dst_unused:UNUSED_PAD src0_sel:WORD_1 src1_sel:DWORD
  v_add_u32_sdwa v205, v205, v218 dst_sel:DWORD dst_unused:UNUSED_PAD src0_sel:WORD_1 src1_sel:DWORD
  v_add_u32_sdwa v206, v206, v218 dst_sel:DWORD dst_unused:UNUSED_PAD src0_sel:WORD_1 src1_sel:DWORD
  v_add_u32_sdwa v207, v207, v218 dst_sel:DWORD dst_unused:UNUSED_PAD src0_sel:WORD_1 src1_sel:DWORD
  v_cvt_pk_bf16_f32 v96, v32, v33
  v_cvt_pk_bf16_f32 v97, v34, v35
  v_cvt_pk_bf16_f32 v98, v36, v37
  v_cvt_pk_bf16_f32 v99, v38, v39
  v_cvt_pk_bf16_f32 v104, v64, v65
  v_cvt_pk_bf16_f32 v105, v66, v67
  v_cvt_pk_bf16_f32 v106, v68, v69
  v_cvt_pk_bf16_f32 v107, v70, v71
  v_mfma_f32_32x32x16_bf16 v[0:15], v[144:147], v[108:111], v[0:15]
  v_exp_f32 v40, v40
  v_exp_f32 v41, v41
  v_exp_f32 v42, v42
  v_mfma_f32_32x32x16_bf16 v[48:63], v[120:123], v[156:159], v[48:63]
  v_exp_f32 v43, v43
  v_exp_f32 v44, v44
  v_exp_f32 v45, v45
  v_exp_f32 v46, v46
  v_exp_f32 v47, v47
  v_pk_add_f32 v[40:41], v[40:41], s[6:7]
  v_pk_add_f32 v[42:43], v[42:43], s[6:7]
  v_pk_add_f32 v[44:45], v[44:45], s[6:7]
  v_pk_add_f32 v[46:47], v[46:47], s[6:7]
  v_mfma_f32_32x32x16_bf16 v[16:31], v[144:147], v[100:103], v[16:31]
  v_rcp_f32 v40, v40
  v_rcp_f32 v41, v41
  v_rcp_f32 v42, v42
  v_mfma_f32_32x32x16_bf16 v[48:63], v[124:127], v[148:151], v[48:63]
  v_rcp_f32 v43, v43
  v_rcp_f32 v44, v44
  v_rcp_f32 v45, v45
  v_rcp_f32 v46, v46
  v_rcp_f32 v47, v47
  v_pk_mul_f32 v[72:73], v[40:41], v[72:73]
  v_pk_mul_f32 v[74:75], v[42:43], v[74:75]
  v_pk_mul_f32 v[76:77], v[44:45], v[76:77]
  v_pk_mul_f32 v[78:79], v[46:47], v[78:79]
  v_mfma_f32_32x32x16_bf16 v[80:95], v[136:139], v[152:155], v[80:95]
  v_cvt_pk_bf16_f32 v100, v40, v41
  v_cvt_pk_bf16_f32 v101, v42, v43
  v_cvt_pk_bf16_f32 v102, v44, v45
  v_mfma_f32_32x32x16_bf16 v[48:63], v[128:131], v[152:155], v[48:63]
  v_cvt_pk_bf16_f32 v103, v46, v47
  v_cvt_pk_bf16_f32 v108, v72, v73
  v_cvt_pk_bf16_f32 v109, v74, v75
  v_cvt_pk_bf16_f32 v110, v76, v77
  v_cvt_pk_bf16_f32 v111, v78, v79
  s_setprio 0
  s_sub_u32 s57, s57, 1
  s_cmp_eq_u32 s57, 0
  s_cbranch_scc1 K2_drain
K2_loop1:
  s_waitcnt vmcnt(5)
  ds_read_b64_tr_b16 v[140:141], v204
  ds_read_b64_tr_b16 v[142:143], v205
  ds_read_b64_tr_b16 v[144:145], v206
  ds_read_b64_tr_b16 v[146:147], v207
  ds_read_b128 v[112:115], v202 offset:0
  ds_read_b128 v[116:119], v202 offset:32
  ds_read_b128 v[120:123], v216 offset:0
  ds_read_b128 v[124:127], v212 offset:0
  ds_read_b128 v[132:135], v214 offset:0
  ds_read_b128 v[128:131], v213 offset:0
  ds_read_b128 v[136:139], v215 offset:0
  s_waitcnt lgkmcnt(4)
  ds_read_u16 v192, v208 offset:512
  ds_read_u16 v194, v208 offset:516
  ds_read_u16 v196, v208 offset:520
  ds_read_u16 v198, v208 offset:524
  ds_read_b32 v200, v209 offset:512
  ds_read_b32 v203, v210 offset:384
  ds_read_b128 v[204:207], v211 offset:128
  s_waitcnt lgkmcnt(2)
  s_add_u32 m0, s58, 0
  s_nop 0
  buffer_load_dwordx4 v[192:193], s[16:19], s36 idxen offen offset:0 lds
  buffer_load_dwordx4 v[194:195], s[16:19], s37 idxen offen offset:1024 lds
  buffer_load_dwordx4 v[196:197], s[16:19], s38 idxen offen offset:2048 lds
  buffer_load_dwordx4 v[198:199], s[16:19], 0 idxen offen offset:3072 lds
  s_add_u32 m0, s58, 4096
  s_nop 0
  buffer_load_dwordx4 v[200:201], s[12:15], 0 idxen offen lds
  s_waitcnt lgkmcnt(0)
  s_setprio 1
  v_mfma_f32_32x32x16_bf16 v[0:15], v[140:143], v[104:107], v[0:15]
  v_exp_f32 v48, v48
  v_exp_f32 v49, v49
  v_exp_f32 v50, v50
  v_mfma_f32_32x32x16_bf16 v[16:31], v[140:143], v[96:99], v[16:31]
  v_exp_f32 v51, v51
  v_exp_f32 v52, v52
  v_exp_f32 v53, v53
  v_exp_f32 v54, v54
  v_exp_f32 v55, v55
  s_setprio 2
  v_pk_add_f32 v[48:49], v[48:49], s[6:7]
  v_pk_add_f32 v[50:51], v[50:51], s[6:7]
  v_pk_add_f32 v[52:53], v[52:53], s[6:7]
  v_pk_add_f32 v[54:55], v[54:55], s[6:7]
  v_mfma_f32_32x32x16_bf16 v[32:47], v[112:115], v[160:163], 0
  v_rcp_f32 v48, v48
  v_rcp_f32 v49, v49
  v_rcp_f32 v50, v50
  v_mfma_f32_32x32x16_bf16 v[64:79], v[132:135], v[148:151], 0
  v_rcp_f32 v51, v51
  v_rcp_f32 v52, v52
  v_rcp_f32 v53, v53
  v_rcp_f32 v54, v54
  v_rcp_f32 v55, v55
  s_setprio 3
  v_pk_mul_f32 v[80:81], v[48:49], v[80:81]
  v_pk_mul_f32 v[82:83], v[50:51], v[82:83]
  v_pk_mul_f32 v[84:85], v[52:53], v[84:85]
  v_pk_mul_f32 v[86:87], v[54:55], v[86:87]
  v_mfma_f32_32x32x16_bf16 v[32:47], v[116:119], v[164:167], v[32:47]
  v_add_u32_sdwa v202, v203, v217 dst_sel:DWORD dst_unused:UNUSED_PAD src0_sel:WORD_1 src1_sel:DWORD
  v_add_u32_sdwa v204, v204, v218 dst_sel:DWORD dst_unused:UNUSED_PAD src0_sel:WORD_1 src1_sel:DWORD
  v_add_u32_sdwa v205, v205, v218 dst_sel:DWORD dst_unused:UNUSED_PAD src0_sel:WORD_1 src1_sel:DWORD
  v_add_u32_sdwa v206, v206, v218 dst_sel:DWORD dst_unused:UNUSED_PAD src0_sel:WORD_1 src1_sel:DWORD
  v_add_u32_sdwa v207, v207, v218 dst_sel:DWORD dst_unused:UNUSED_PAD src0_sel:WORD_1 src1_sel:DWORD
  v_cvt_pk_bf16_f32 v96, v48, v49
  v_cvt_pk_bf16_f32 v97, v50, v51
  v_cvt_pk_bf16_f32 v98, v52, v53
  v_cvt_pk_bf16_f32 v99, v54, v55
  v_cvt_pk_bf16_f32 v104, v80, v81
  v_cvt_pk_bf16_f32 v105, v82, v83
  v_cvt_pk_bf16_f32 v106, v84, v85
  v_cvt_pk_bf16_f32 v107, v86, v87
  v_mfma_f32_32x32x16_bf16 v[0:15], v[144:147], v[108:111], v[0:15]
  v_exp_f32 v56, v56
  v_exp_f32 v57, v57
  v_exp_f32 v58, v58
  v_mfma_f32_32x32x16_bf16 v[32:47], v[120:123], v[156:159], v[32:47]
  v_exp_f32 v59, v59
  v_exp_f32 v60, v60
  v_exp_f32 v61, v61
  v_exp_f32 v62, v62
  v_exp_f32 v63, v63
  v_pk_add_f32 v[56:57], v[56:57], s[6:7]
  v_pk_add_f32 v[58:59], v[58:59], s[6:7]
  v_pk_add_f32 v[60:61], v[60:61], s[6:7]
  v_pk_add_f32 v[62:63], v[62:63], s[6:7]
  v_mfma_f32_32x32x16_bf16 v[16:31], v[144:147], v[100:103], v[16:31]
  v_rcp_f32 v56, v56
  v_rcp_f32 v57, v57
  v_rcp_f32 v58, v58
  v_mfma_f32_32x32x16_bf16 v[32:47], v[124:127], v[148:151], v[32:47]
  v_rcp_f32 v59, v59
  v_rcp_f32 v60, v60
  v_rcp_f32 v61, v61
  v_rcp_f32 v62, v62
  v_rcp_f32 v63, v63
  v_pk_mul_f32 v[88:89], v[56:57], v[88:89]
  v_pk_mul_f32 v[90:91], v[58:59], v[90:91]
  v_pk_mul_f32 v[92:93], v[60:61], v[92:93]
  v_pk_mul_f32 v[94:95], v[62:63], v[94:95]
  v_mfma_f32_32x32x16_bf16 v[64:79], v[136:139], v[152:155], v[64:79]
  v_cvt_pk_bf16_f32 v100, v56, v57
  v_cvt_pk_bf16_f32 v101, v58, v59
  v_cvt_pk_bf16_f32 v102, v60, v61
  v_mfma_f32_32x32x16_bf16 v[32:47], v[128:131], v[152:155], v[32:47]
  v_cvt_pk_bf16_f32 v103, v62, v63
  v_cvt_pk_bf16_f32 v108, v88, v89
  v_cvt_pk_bf16_f32 v109, v90, v91
  v_cvt_pk_bf16_f32 v110, v92, v93
  v_cvt_pk_bf16_f32 v111, v94, v95
  v_add_u32 v208, 256, v208
  v_add_u32 v209, 256, v209
  v_add_u32 v210, 256, v210
  v_add_u32 v211, 256, v211
  s_setprio 0
  s_sub_u32 s57, s57, 1
  s_cmp_lg_u32 s57, 0
  s_cbranch_scc1 K2_loop
K2_drain:
  ds_read_b64_tr_b16 v[140:141], v204
  ds_read_b64_tr_b16 v[142:143], v205
  ds_read_b64_tr_b16 v[144:145], v206
  ds_read_b64_tr_b16 v[146:147], v207
  s_waitcnt lgkmcnt(0)
  v_mfma_f32_32x32x16_bf16 v[0:15], v[140:143], v[104:107], v[0:15]
  v_mfma_f32_32x32x16_bf16 v[16:31], v[140:143], v[96:99], v[16:31]
  v_mfma_f32_32x32x16_bf16 v[0:15], v[144:147], v[108:111], v[0:15]
  v_mfma_f32_32x32x16_bf16 v[16:31], v[144:147], v[100:103], v[16:31]
K2_roundend:
  s_add_u32 s55, s55, 512
  s_cmp_lt_u32 s55, s56
  s_cbranch_scc1 K2_more
  s_waitcnt vmcnt(0)
  v_and_b32 v232, 31, v219
  v_lshrrev_b32 v233, 5, v219
  v_lshlrev_b32 v234, 10, v233
  v_lshl_add_u32 v238, v232, 1, v234
  s_mov_b32 s4, 0x358637bd
  v_lshlrev_b32 v180, 16, v180
  v_lshlrev_b32 v181, 16, v181
  v_lshlrev_b32 v182, 16, v182
  v_lshlrev_b32 v183, 16, v183
  v_lshlrev_b32 v184, 16, v184
  v_lshlrev_b32 v185, 16, v185
  v_lshlrev_b32 v186, 16, v186
  v_lshlrev_b32 v187, 16, v187
  v_lshlrev_b32 v188, 16, v188
  v_lshlrev_b32 v189, 16, v189
  v_lshlrev_b32 v190, 16, v190
  v_lshlrev_b32 v191, 16, v191
  s_add_u32 s5, s63, 4096
  s_nop 1
  v_add_f32 v16, s4, v16
  v_add_f32 v17, s4, v17
  v_add_f32 v18, s4, v18
  v_add_f32 v19, s4, v19
  v_add_f32 v20, s4, v20
  v_add_f32 v21, s4, v21
  v_add_f32 v22, s4, v22
  v_add_f32 v23, s4, v23
  v_add_f32 v24, s4, v24
  v_add_f32 v25, s4, v25
  v_add_f32 v26, s4, v26
  v_add_f32 v27, s4, v27
  v_rcp_f32 v16, v16
  v_rcp_f32 v17, v17
  v_rcp_f32 v18, v18
  v_rcp_f32 v19, v19
  v_rcp_f32 v20, v20
  v_rcp_f32 v21, v21
  v_rcp_f32 v22, v22
  v_rcp_f32 v23, v23
  v_rcp_f32 v24, v24
  v_rcp_f32 v25, v25
  v_rcp_f32 v26, v26
  v_rcp_f32 v27, v27
  v_fma_f32 v0, v0, v16, v168
  v_fma_f32 v1, v1, v17, v169
  v_fma_f32 v2, v2, v18, v170
  v_fma_f32 v3, v3, v19, v171
  v_fma_f32 v4, v4, v20, v172
  v_fma_f32 v5, v5, v21, v173
  v_fma_f32 v6, v6, v22, v174
  v_fma_f32 v7, v7, v23, v175
  v_fma_f32 v8, v8, v24, v176
  v_fma_f32 v9, v9, v25, v177
  v_fma_f32 v10, v10, v26, v178
  v_fma_f32 v11, v11, v27, v179
  v_max_f32 v0, 0, v0
  v_max_f32 v1, 0, v1
  v_max_f32 v2, 0, v2
  v_max_f32 v3, 0, v3
  v_max_f32 v4, 0, v4
  v_max_f32 v5, 0, v5
  v_max_f32 v6, 0, v6
  v_max_f32 v7, 0, v7
  v_max_f32 v8, 0, v8
  v_max_f32 v9, 0, v9
  v_max_f32 v10, 0, v10
  v_max_f32 v11, 0, v11
  v_add_f32 v0, v0, v180
  v_add_f32 v1, v1, v181
  v_add_f32 v2, v2, v182
  v_add_f32 v3, v3, v183
  v_add_f32 v4, v4, v184
  v_add_f32 v5, v5, v185
  v_add_f32 v6, v6, v186
  v_add_f32 v7, v7, v187
  v_add_f32 v8, v8, v188
  v_add_f32 v9, v9, v189
  v_add_f32 v10, v10, v190
  v_add_f32 v11, v11, v191
  v_cvt_pk_bf16_f32 v16, v0, v1
  v_cvt_pk_bf16_f32 v17, v2, v3
  v_cvt_pk_bf16_f32 v18, v4, v5
  v_cvt_pk_bf16_f32 v19, v6, v7
  v_cvt_pk_bf16_f32 v20, v8, v9
  v_cvt_pk_bf16_f32 v21, v10, v11
  buffer_store_short v16, v238, s[44:47], s63 offen offset:0
  buffer_store_short_d16_hi v16, v238, s[44:47], s63 offen offset:256
  buffer_store_short v17, v238, s[44:47], s63 offen offset:512
  buffer_store_short_d16_hi v17, v238, s[44:47], s63 offen offset:768
  buffer_store_short v18, v238, s[44:47], s63 offen offset:2048
  buffer_store_short_d16_hi v18, v238, s[44:47], s63 offen offset:2304
  buffer_store_short v19, v238, s[44:47], s63 offen offset:2560
  buffer_store_short_d16_hi v19, v238, s[44:47], s63 offen offset:2816
  s_mov_b32 exec_hi, 0
  buffer_store_short v20, v238, s[44:47], s5 offen offset:0
  buffer_store_short_d16_hi v20, v238, s[44:47], s5 offen offset:256
  buffer_store_short v21, v238, s[44:47], s5 offen offset:512
  buffer_store_short_d16_hi v21, v238, s[44:47], s5 offen offset:768
K2_done:
  s_endpgm
K2_more:
  s_waitcnt vmcnt(0) lgkmcnt(0)
  s_barrier
  s_sub_u32 s59, s54, s55
  s_cselect_b32 s59, 0, s59
  s_min_u32 s59, s59, 512
  s_cmp_ge_u32 s3, 4
  s_cbranch_scc1 K2_more2
  s_sub_u32 s71, s70, s55
  s_cselect_b32 s71, 0, s71
  s_min_u32 s71, s71, 512
  v_lshl_add_u32 v228, v219, 2, s67
  v_mov_b32 v229, 0x640ffff
  v_mov_b32 v230, -1
  ds_write_b32 v228, v229 offset:0
  ds_write_b32 v228, v229 offset:256
  ds_write_b32 v228, v229 offset:512
  ds_write_b32 v228, v229 offset:768
  ds_write_b32 v228, v229 offset:1024
  ds_write_b32 v228, v229 offset:1280
  ds_write_b32 v228, v229 offset:1536
  ds_write_b32 v228, v229 offset:1792
  ds_write_b32 v228, v230 offset:2432
  ds_write_b32 v228, v230 offset:2688
  ds_write_b32 v228, v230 offset:2944
  ds_write_b32 v228, v230 offset:3200
  ds_write_b32 v228, v230 offset:3456
  ds_write_b32 v228, v230 offset:3712
  ds_write_b32 v228, v230 offset:3968
  ds_write_b32 v228, v230 offset:4224
  v_sub_u32 v227, s55, v248
  v_max_i32 v227, 0, v227
  v_add_u32 v231, v248, v227
  v_subrev_u32 v231, s55, v231
  v_add_u32 v232, v244, v227
  s_add_u32 s4, s67, 2432
  s_movk_i32 s5, 512
K2_genloop10:
  v_cmp_lt_u32 vcc, v227, v240
  v_cmp_gt_u32 s[60:61], s5, v231
  s_nop 3
  s_and_b64 exec, vcc, s[60:61]
  s_cbranch_execz K2_gendone10
  v_lshl_add_u32 v233, v231, 2, s4
  ds_write_b32 v233, v232
  v_add_u32 v227, 1, v227
  v_add_u32 v231, 1, v231
  v_add_u32 v232, 1, v232
  s_mov_b64 exec, -1
  s_branch K2_genloop10
K2_gendone10:
  s_mov_b64 exec, -1
  v_sub_u32 v227, s55, v249
  v_max_i32 v227, 0, v227
  v_add_u32 v231, v249, v227
  v_subrev_u32 v231, s55, v231
  v_add_u32 v232, v245, v227
  s_add_u32 s4, s67, 2432
  s_movk_i32 s5, 512
K2_genloop11:
  v_cmp_lt_u32 vcc, v227, v241
  v_cmp_gt_u32 s[60:61], s5, v231
  s_nop 3
  s_and_b64 exec, vcc, s[60:61]
  s_cbranch_execz K2_gendone11
  v_lshl_add_u32 v233, v231, 2, s4
  ds_write_b32 v233, v232
  v_add_u32 v227, 1, v227
  v_add_u32 v231, 1, v231
  v_add_u32 v232, 1, v232
  s_mov_b64 exec, -1
  s_branch K2_genloop11
K2_gendone11:
  s_mov_b64 exec, -1
  v_sub_u32 v227, s55, v250
  v_max_i32 v227, 0, v227
  v_add_u32 v231, v250, v227
  v_subrev_u32 v231, s55, v231
  v_add_u32 v232, v246, v227
  s_add_u32 s4, s67, 2432
  s_movk_i32 s5, 512
K2_genloop12:
  v_cmp_lt_u32 vcc, v227, v242
  v_cmp_gt_u32 s[60:61], s5, v231
  s_nop 3
  s_and_b64 exec, vcc, s[60:61]
  s_cbranch_execz K2_gendone12
  v_lshl_add_u32 v233, v231, 2, s4
  ds_write_b32 v233, v232
  v_add_u32 v227, 1, v227
  v_add_u32 v231, 1, v231
  v_add_u32 v232, 1, v232
  s_mov_b64 exec, -1
  s_branch K2_genloop12
K2_gendone12:
  s_mov_b64 exec, -1
  v_sub_u32 v227, s55, v251
  v_max_i32 v227, 0, v227
  v_add_u32 v231, v251, v227
  v_subrev_u32 v231, s55, v231
  v_add_u32 v232, v247, v227
  s_add_u32 s4, s67, 2432
  s_movk_i32 s5, 512
K2_genloop13:
  v_cmp_lt_u32 vcc, v227, v243
  v_cmp_gt_u32 s[60:61], s5, v231
  s_nop 3
  s_and_b64 exec, vcc, s[60:61]
  s_cbranch_execz K2_gendone13
  v_lshl_add_u32 v233, v231, 2, s4
  ds_write_b32 v233, v232
  v_add_u32 v227, 1, v227
  v_add_u32 v231, 1, v231
  v_add_u32 v232, 1, v232
  s_mov_b64 exec, -1
  s_branch K2_genloop13
K2_gendone13:
  s_mov_b64 exec, -1
  v_lshl_add_u32 v231, v219, 2, s67
  s_waitcnt lgkmcnt(0)
  ds_read_b32 v232, v231 offset:2432
  ds_read_b32 v233, v231 offset:2688
  ds_read_b32 v234, v231 offset:2944
  ds_read_b32 v235, v231 offset:3200
  ds_read_b32 v236, v231 offset:3456
  ds_read_b32 v237, v231 offset:3712
  ds_read_b32 v238, v231 offset:3968
  ds_read_b32 v239, v231 offset:4224
  v_mov_b32 v231, v219
  v_cmp_gt_u32 s[20:21], s71, v231
  v_add_u32 v231, 64, v231
  v_cmp_gt_u32 s[22:23], s71, v231
  v_add_u32 v231, 64, v231
  v_cmp_gt_u32 s[24:25], s71, v231
  v_add_u32 v231, 64, v231
  v_cmp_gt_u32 s[26:27], s71, v231
  v_add_u32 v231, 64, v231
  v_cmp_gt_u32 s[28:29], s71, v231
  v_add_u32 v231, 64, v231
  v_cmp_gt_u32 s[30:31], s71, v231
  v_add_u32 v231, 64, v231
  v_cmp_gt_u32 s[64:65], s71, v231
  v_add_u32 v231, 64, v231
  v_cmp_gt_u32 s[68:69], s71, v231
  v_add_u32 v231, 64, v231
  s_waitcnt lgkmcnt(0)
  v_lshlrev_b32 v40, 2, v232
  v_lshlrev_b32 v41, 2, v233
  v_lshlrev_b32 v42, 2, v234
  v_lshlrev_b32 v43, 2, v235
  v_lshlrev_b32 v44, 2, v236
  v_lshlrev_b32 v45, 2, v237
  v_lshlrev_b32 v46, 2, v238
  v_lshlrev_b32 v47, 2, v239
  s_cmp_eq_u64 s[20:21], 0
  s_cbranch_scc1 K2_recldM
  s_mov_b64 exec, s[20:21]
  buffer_load_dword v32, v40, s[32:35], 0 offen
  s_cmp_eq_u64 s[22:23], 0
  s_cbranch_scc1 K2_recldM
  s_mov_b64 exec, s[22:23]
  buffer_load_dword v33, v41, s[32:35], 0 offen
  s_cmp_eq_u64 s[24:25], 0
  s_cbranch_scc1 K2_recldM
  s_mov_b64 exec, s[24:25]
  buffer_load_dword v34, v42, s[32:35], 0 offen
  s_cmp_eq_u64 s[26:27], 0
  s_cbranch_scc1 K2_recldM
  s_mov_b64 exec, s[26:27]
  buffer_load_dword v35, v43, s[32:35], 0 offen
  s_cmp_eq_u64 s[28:29], 0
  s_cbranch_scc1 K2_recldM
  s_mov_b64 exec, s[28:29]
  buffer_load_dword v36, v44, s[32:35], 0 offen
  s_cmp_eq_u64 s[30:31], 0
  s_cbranch_scc1 K2_recldM
  s_mov_b64 exec, s[30:31]
  buffer_load_dword v37, v45, s[32:35], 0 offen
  s_cmp_eq_u64 s[64:65], 0
  s_cbranch_scc1 K2_recldM
  s_mov_b64 exec, s[64:65]
  buffer_load_dword v38, v46, s[32:35], 0 offen
  s_cmp_eq_u64 s[68:69], 0
  s_cbranch_scc1 K2_recldM
  s_mov_b64 exec, s[68:69]
  buffer_load_dword v39, v47, s[32:35], 0 offen
K2_recldM:
  s_mov_b64 exec, -1
  s_waitcnt vmcnt(0)
  s_mov_b32 s5, 0x500000
  s_mov_b32 s6, 6710887
  s_movk_i32 s7, 640
  s_cmp_eq_u64 s[20:21], 0
  s_cbranch_scc1 K2_unpM
  v_mul_hi_u32 v232, v232, s6
  v_lshrrev_b32 v230, 19, v32
  v_mad_u32_u24 v232, v232, s7, v230
  v_bfe_u32 v230, v32, 14, 5
  v_and_b32 v32, 0x3fff, v32
  v_mad_u32_u24 v32, v230, s5, v32
  s_cmp_eq_u64 s[22:23], 0
  s_cbranch_scc1 K2_unpM
  v_mul_hi_u32 v233, v233, s6
  v_lshrrev_b32 v230, 19, v33
  v_mad_u32_u24 v233, v233, s7, v230
  v_bfe_u32 v230, v33, 14, 5
  v_and_b32 v33, 0x3fff, v33
  v_mad_u32_u24 v33, v230, s5, v33
  s_cmp_eq_u64 s[24:25], 0
  s_cbranch_scc1 K2_unpM
  v_mul_hi_u32 v234, v234, s6
  v_lshrrev_b32 v230, 19, v34
  v_mad_u32_u24 v234, v234, s7, v230
  v_bfe_u32 v230, v34, 14, 5
  v_and_b32 v34, 0x3fff, v34
  v_mad_u32_u24 v34, v230, s5, v34
  s_cmp_eq_u64 s[26:27], 0
  s_cbranch_scc1 K2_unpM
  v_mul_hi_u32 v235, v235, s6
  v_lshrrev_b32 v230, 19, v35
  v_mad_u32_u24 v235, v235, s7, v230
  v_bfe_u32 v230, v35, 14, 5
  v_and_b32 v35, 0x3fff, v35
  v_mad_u32_u24 v35, v230, s5, v35
  s_cmp_eq_u64 s[28:29], 0
  s_cbranch_scc1 K2_unpM
  v_mul_hi_u32 v236, v236, s6
  v_lshrrev_b32 v230, 19, v36
  v_mad_u32_u24 v236, v236, s7, v230
  v_bfe_u32 v230, v36, 14, 5
  v_and_b32 v36, 0x3fff, v36
  v_mad_u32_u24 v36, v230, s5, v36
  s_cmp_eq_u64 s[30:31], 0
  s_cbranch_scc1 K2_unpM
  v_mul_hi_u32 v237, v237, s6
  v_lshrrev_b32 v230, 19, v37
  v_mad_u32_u24 v237, v237, s7, v230
  v_bfe_u32 v230, v37, 14, 5
  v_and_b32 v37, 0x3fff, v37
  v_mad_u32_u24 v37, v230, s5, v37
  s_cmp_eq_u64 s[64:65], 0
  s_cbranch_scc1 K2_unpM
  v_mul_hi_u32 v238, v238, s6
  v_lshrrev_b32 v230, 19, v38
  v_mad_u32_u24 v238, v238, s7, v230
  v_bfe_u32 v230, v38, 14, 5
  v_and_b32 v38, 0x3fff, v38
  v_mad_u32_u24 v38, v230, s5, v38
  s_cmp_eq_u64 s[68:69], 0
  s_cbranch_scc1 K2_unpM
  v_mul_hi_u32 v239, v239, s6
  v_lshrrev_b32 v230, 19, v39
  v_mad_u32_u24 v239, v239, s7, v230
  v_bfe_u32 v230, v39, 14, 5
  v_and_b32 v39, 0x3fff, v39
  v_mad_u32_u24 v39, v230, s5, v39
K2_unpM:
  v_lshl_add_u32 v231, v219, 2, s67
  s_cmp_eq_u64 s[20:21], 0
  s_cbranch_scc1 K2_plainM
  s_mov_b64 exec, s[20:21]
  ds_write_b32 v231, v32 offset:0
  ds_write_b32 v231, v232 offset:2432
  s_cmp_eq_u64 s[22:23], 0
  s_cbranch_scc1 K2_plainM
  s_mov_b64 exec, s[22:23]
  ds_write_b32 v231, v33 offset:256
  ds_write_b32 v231, v233 offset:2688
  s_cmp_eq_u64 s[24:25], 0
  s_cbranch_scc1 K2_plainM
  s_mov_b64 exec, s[24:25]
  ds_write_b32 v231, v34 offset:512
  ds_write_b32 v231, v234 offset:2944
  s_cmp_eq_u64 s[26:27], 0
  s_cbranch_scc1 K2_plainM
  s_mov_b64 exec, s[26:27]
  ds_write_b32 v231, v35 offset:768
  ds_write_b32 v231, v235 offset:3200
  s_cmp_eq_u64 s[28:29], 0
  s_cbranch_scc1 K2_plainM
  s_mov_b64 exec, s[28:29]
  ds_write_b32 v231, v36 offset:1024
  ds_write_b32 v231, v236 offset:3456
  s_cmp_eq_u64 s[30:31], 0
  s_cbranch_scc1 K2_plainM
  s_mov_b64 exec, s[30:31]
  ds_write_b32 v231, v37 offset:1280
  ds_write_b32 v231, v237 offset:3712
  s_cmp_eq_u64 s[64:65], 0
  s_cbranch_scc1 K2_plainM
  s_mov_b64 exec, s[64:65]
  ds_write_b32 v231, v38 offset:1536
  ds_write_b32 v231, v238 offset:3968
  s_cmp_eq_u64 s[68:69], 0
  s_cbranch_scc1 K2_plainM
  s_mov_b64 exec, s[68:69]
  ds_write_b32 v231, v39 offset:1792
  ds_write_b32 v231, v239 offset:4224
K2_plainM:
  s_mov_b64 exec, -1
K2_more2:
  v_lshrrev_b32 v232, 3, v219
  v_lshl_add_u32 v208, v232, 4, s62
  v_bfe_u32 v233, v219, 1, 3
  v_lshrrev_b32 v232, 4, v219
  v_lshl_add_u32 v233, v233, 2, v232
  s_add_u32 s4, s62, 2432
  v_lshl_add_u32 v209, v233, 2, s4
  v_and_b32 v233, 7, v219
  v_bfe_u32 v232, v219, 3, 2
  v_lshl_add_u32 v233, v233, 2, v232
  v_lshl_add_u32 v210, v233, 2, s62
  v_lshrrev_b32 v232, 5, v219
  v_bfe_u32 v233, v219, 2, 2
  v_lshl_add_u32 v232, v232, 2, v233
  v_lshl_add_u32 v211, v232, 4, s62
  v_mov_b32 v96, 0
  v_mov_b32 v97, 0
  v_mov_b32 v98, 0
  v_mov_b32 v99, 0
  v_mov_b32 v100, 0
  v_mov_b32 v101, 0
  v_mov_b32 v102, 0
  v_mov_b32 v103, 0
  v_mov_b32 v104, 0
  v_mov_b32 v105, 0
  v_mov_b32 v106, 0
  v_mov_b32 v107, 0
  v_mov_b32 v108, 0
  v_mov_b32 v109, 0
  v_mov_b32 v110, 0
  v_mov_b32 v111, 0
  s_waitcnt vmcnt(0) lgkmcnt(0)
  s_barrier
  ds_read_u16 v192, v208 offset:0
  ds_read_u16 v194, v208 offset:4
  ds_read_u16 v196, v208 offset:8
  ds_read_u16 v198, v208 offset:12
  ds_read_b32 v200, v209 offset:0
  ds_read_b32 v203, v210 offset:0
  s_waitcnt lgkmcnt(1)
  s_add_u32 m0, s58, 0
  s_nop 0
  buffer_load_dwordx4 v[192:193], s[16:19], s36 idxen offen offset:0 lds
  buffer_load_dwordx4 v[194:195], s[16:19], s37 idxen offen offset:1024 lds
  buffer_load_dwordx4 v[196:197], s[16:19], s38 idxen offen offset:2048 lds
  buffer_load_dwordx4 v[198:199], s[16:19], 0 idxen offen offset:3072 lds
  s_add_u32 m0, s58, 4096
  s_nop 0
  buffer_load_dwordx4 v[200:201], s[12:15], 0 idxen offen lds
  ds_read_u16 v192, v208 offset:128
  ds_read_u16 v194, v208 offset:132
  ds_read_u16 v196, v208 offset:136
  ds_read_u16 v198, v208 offset:140
  ds_read_b32 v200, v209 offset:128
  s_waitcnt lgkmcnt(0)
  s_add_u32 m0, s58, 5120
  s_nop 0
  buffer_load_dwordx4 v[192:193], s[16:19], s36 idxen offen offset:0 lds
  buffer_load_dwordx4 v[194:195], s[16:19], s37 idxen offen offset:1024 lds
  buffer_load_dwordx4 v[196:197], s[16:19], s38 idxen offen offset:2048 lds
  buffer_load_dwordx4 v[198:199], s[16:19], 0 idxen offen offset:3072 lds
  s_add_u32 m0, s58, 9216
  s_nop 0
  buffer_load_dwordx4 v[200:201], s[12:15], 0 idxen offen lds
  v_add_u32_sdwa v202, v203, v217 dst_sel:DWORD dst_unused:UNUSED_PAD src0_sel:WORD_1 src1_sel:DWORD
  s_branch K2_window
K2_codeend:
.section .rodata,"a"
.p2align 6
.amdhsa_kernel prep_kernel
  .amdhsa_next_free_vgpr 124
  .amdhsa_next_free_sgpr 64
  .amdhsa_accum_offset 124
  .amdhsa_group_segment_fixed_size 0
  .amdhsa_kernarg_size 96
  .amdhsa_user_sgpr_count 2
  .amdhsa_user_sgpr_kernarg_segment_ptr 1
  .amdhsa_system_sgpr_workgroup_id_x 1
.end_amdhsa_kernel
.p2align 6
.amdhsa_kernel gather_scatter__edge_featured_mpnn_gatedgcn__graph_kernel
  .amdhsa_next_free_vgpr 253
  .amdhsa_next_free_sgpr 102
  .amdhsa_accum_offset 256
  .amdhsa_group_segment_fixed_size 0
  .amdhsa_kernarg_size 96
  .amdhsa_user_sgpr_count 2
  .amdhsa_user_sgpr_kernarg_segment_ptr 1
  .amdhsa_system_sgpr_workgroup_id_x 1
.end_amdhsa_kernel
```
